```python
import torch

def _softmax(x, axis=-1):
    return torch.softmax(x, dim=axis)
def _gelu(x):
    return torch.nn.functional.gelu(x, approximate="tanh")
def _silu(x):
    return torch.nn.functional.silu(x)
def _sigmoid(x):
    return torch.sigmoid(x)
def _layernorm(x, axis=-1, eps=1e-5):
    m = x.mean(dim=axis, keepdim=True)
    v = x.var(dim=axis, keepdim=True, unbiased=False)
    return (x - m) / torch.sqrt(v + eps)
def _scatter_add(tgt, idx, src, axis=0):
    return tgt.clone().index_add_(axis, idx, src)
def _segment_sum(src, seg, n):
    out = torch.zeros((n,) + src.shape[1:], dtype=src.dtype)
    return out.index_add_(0, seg, src)
def _pad(x, pw):
    flat = tuple(v for pair in reversed(pw) for v in pair)
    return torch.nn.functional.pad(x, flat)

kernel_name = 'standalone__adm_resblock__diffusion'

def setup_inputs():

    _w = (lambda a: (lambda t: t.to(torch.bfloat16) if t.is_floating_point() else t)(torch.as_tensor(a)))
    B, C, HW, E = 2, 512, 32, 768
    sc = (9.0 * C) ** -0.5
    return {
        "x": _w((lambda *s: torch.randn(*s, dtype=torch.bfloat16) * 0.05)(B, C, HW, HW)),
        "t_emb": _w((lambda *s: torch.randn(*s, dtype=torch.bfloat16) * 0.4)(B, E)),
        "g1": _w(1.0 + 0.1 * (lambda *s: torch.randn(*s, dtype=torch.bfloat16) * 0.4)(C)),
        "be1": _w(0.1 * (lambda *s: torch.randn(*s, dtype=torch.bfloat16) * 0.4)(C)),
        "w1": _w((lambda *s: torch.randn(*s, dtype=torch.bfloat16) * 0.4)(C, C, 3, 3) * sc),
        "w_emb": _w((lambda *s: torch.randn(*s, dtype=torch.bfloat16) * 0.4)(E, C) * (E ** -0.5)),
        "g2": _w(1.0 + 0.1 * (lambda *s: torch.randn(*s, dtype=torch.bfloat16) * 0.4)(C)),
        "be2": _w(0.1 * (lambda *s: torch.randn(*s, dtype=torch.bfloat16) * 0.4)(C)),
        "w2": _w((lambda *s: torch.randn(*s, dtype=torch.bfloat16) * 0.4)(C, C, 3, 3) * sc),
    }

def reference(x, t_emb, g1, be1, w1, w_emb, g2, be2, w2):
    B, C, H, W = x.shape
    G, eps = 4, 1e-5
    def gn(z, gamma, beta):
        zr = z.reshape(B, G, (C // G) * H * W)
        mu = zr.mean(-1).reshape(B, G, 1)
        var = ((zr - mu) ** 2).mean(-1).reshape(B, G, 1)
        zn = ((zr - mu) / torch.sqrt(var + eps)).reshape(B, C, H, W)
        return zn * gamma.reshape(1, C, 1, 1) + beta.reshape(1, C, 1, 1)
    def conv3(z, w):
        zp = _pad(z, ((0, 0), (0, 0), (1, 1), (1, 1)))
        taps = [torch.einsum("bchw,oc->bohw", zp[:, :, i:i+H, j:j+W], w[:, :, i, j]) for i in range(3) for j in range(3)]
        out = taps[0]
        for t in taps[1:]:
            out = out + t
        return out
    h = conv3(_silu(gn(x, g1, be1)), w1)
    emb = _silu(t_emb) @ w_emb
    h = h + emb.reshape(B, C, 1, 1)
    h = conv3(_silu(gn(h, g2, be2)), w2)
    return x + h
```

```asm
; @launch grid=(256,1,1) block=(256,1,1) lds=163840
.amdgcn_target "amdgcn-amd-amdhsa--gfx950"
.text
.globl standalone__adm_resblock__diffusion_kernel
.p2align 8
.type standalone__adm_resblock__diffusion_kernel,@function
standalone__adm_resblock__diffusion_kernel:
    s_cmp_ge_u32 s2, 256
    s_cbranch_scc1 L_end
    s_load_dwordx16 s[4:19], s[0:1], 0
    s_load_dwordx8 s[20:27], s[0:1], 64
    s_memrealtime s[94:95]
    v_lshrrev_b32 v1, 6, v0
    v_and_b32 v2, 63, v0
    v_readfirstlane_b32 s44, v1
    s_and_b32 s45, s2, 7
    s_lshr_b32 s46, s2, 3
    s_lshr_b32 s47, s45, 2
    s_and_b32 s48, s45, 3
    s_and_b32 s49, s46, 3
    s_lshr_b32 s50, s46, 2
    s_lshl_b32 s51, s48, 7
    s_lshl_b32 s68, s49, 5
    s_add_u32 s51, s51, s68
    s_lshl_b32 s52, s50, 2
    s_mul_i32 s53, s44, 40960
    s_lshl_b32 s84, s45, 5
    s_add_u32 s84, s84, s46
    s_lshr_b32 s85, s84, 1
    v_lshlrev_b32 v3, 1, v2
    v_lshl_add_u32 v3, v1, 9, v3
    v_lshlrev_b32 v31, 4, v2
    s_lshl_b32 s72, s85, 14
    s_lshl_b32 s74, s44, 12
    s_add_u32 s88, s72, s74
    s_add_u32 s88, s88, 65536
    s_and_b32 s73, s85, 63
    s_lshl_b32 s73, s73, 4
    s_or_b32 s75, s2, s44
    s_mov_b32 s80, 0xbfb8aa3b
    s_mov_b32 s81, 0xbfb8aa3b
    s_mov_b32 s82, 1.0
    s_mov_b32 s83, 1.0
    s_waitcnt lgkmcnt(0)
    s_mov_b32 s40, s24
    s_and_b32 s41, s25, 0xffff
    s_mov_b32 s42, 256
    s_mov_b32 s43, 0x20000
    s_cmp_lg_u32 s75, 0
    s_cbranch_scc1 L_noep
    s_or_b32 s94, s94, 1
    v_mov_b32 v5, s94
    v_mov_b32 v4, 0
    buffer_store_dword v5, v4, s[40:43], 0 offen sc1
L_noep:
    s_mov_b32 s32, s4
    s_and_b32 s33, s5, 0xffff
    s_mov_b32 s34, 2097152
    s_mov_b32 s35, 0x20000
    s_mov_b32 s28, s26
    s_and_b32 s29, s27, 0xffff
    s_mov_b32 s30, 8388608
    s_mov_b32 s31, 0x20000
    s_bitcmp1_b32 s46, 0
    s_cbranch_scc1 L_warm
    buffer_load_ushort v216, v3, s[32:35], s72 offen offset:0
    buffer_load_ushort v224, v3, s[32:35], s72 offen offset:128
    buffer_load_ushort v232, v3, s[32:35], s72 offen offset:256
    buffer_load_ushort v240, v3, s[32:35], s72 offen offset:384
    buffer_load_ushort v217, v3, s[32:35], s72 offen offset:2048
    buffer_load_ushort v225, v3, s[32:35], s72 offen offset:2176
    buffer_load_ushort v233, v3, s[32:35], s72 offen offset:2304
    buffer_load_ushort v241, v3, s[32:35], s72 offen offset:2432
    s_add_u32 s72, s72, 4096
    buffer_load_ushort v218, v3, s[32:35], s72 offen offset:0
    buffer_load_ushort v226, v3, s[32:35], s72 offen offset:128
    buffer_load_ushort v234, v3, s[32:35], s72 offen offset:256
    buffer_load_ushort v242, v3, s[32:35], s72 offen offset:384
    buffer_load_ushort v219, v3, s[32:35], s72 offen offset:2048
    buffer_load_ushort v227, v3, s[32:35], s72 offen offset:2176
    buffer_load_ushort v235, v3, s[32:35], s72 offen offset:2304
    buffer_load_ushort v243, v3, s[32:35], s72 offen offset:2432
    s_add_u32 s72, s72, 4096
    buffer_load_ushort v220, v3, s[32:35], s72 offen offset:0
    buffer_load_ushort v228, v3, s[32:35], s72 offen offset:128
    buffer_load_ushort v236, v3, s[32:35], s72 offen offset:256
    buffer_load_ushort v244, v3, s[32:35], s72 offen offset:384
    buffer_load_ushort v221, v3, s[32:35], s72 offen offset:2048
    buffer_load_ushort v229, v3, s[32:35], s72 offen offset:2176
    buffer_load_ushort v237, v3, s[32:35], s72 offen offset:2304
    buffer_load_ushort v245, v3, s[32:35], s72 offen offset:2432
    s_add_u32 s72, s72, 4096
    buffer_load_ushort v222, v3, s[32:35], s72 offen offset:0
    buffer_load_ushort v230, v3, s[32:35], s72 offen offset:128
    buffer_load_ushort v238, v3, s[32:35], s72 offen offset:256
    buffer_load_ushort v246, v3, s[32:35], s72 offen offset:384
    buffer_load_ushort v223, v3, s[32:35], s72 offen offset:2048
    buffer_load_ushort v231, v3, s[32:35], s72 offen offset:2176
    buffer_load_ushort v239, v3, s[32:35], s72 offen offset:2304
    buffer_load_ushort v247, v3, s[32:35], s72 offen offset:2432
    s_add_u32 s8, s8, s73
    s_addc_u32 s9, s9, 0
    s_add_u32 s10, s10, s73
    s_addc_u32 s11, s11, 0
    s_load_dwordx4 s[72:75], s[8:9], 0
    s_load_dwordx4 s[76:79], s[10:11], 0
    s_lshl_b32 s68, s45, 10
    s_add_u32 s68, s68, 7471104
    buffer_load_dword v252, v31, s[28:31], s68 offen sc1
    s_lshl_b32 s68, s45, 11
    s_add_u32 s68, s68, 7487488
    buffer_load_dword v252, v31, s[28:31], s68 offen sc1
    buffer_load_dword v252, v31, s[28:31], s68 offen offset:1024 sc1
    v_lshrrev_b32 v4, 2, v2
    v_and_b32 v5, 3, v2
    v_bfe_u32 v6, v4, 3, 1
    v_lshlrev_b32 v6, 1, v6
    v_xor_b32 v5, v5, v6
    s_movk_i32 s68, 9216
    v_add_u32 v4, s51, v4
    v_mul_u32_u24 v4, s68, v4
    v_lshl_add_u32 v4, v5, 4, v4
    v_add_u32 v64, 4096, v4
    v_add_u32 v65, 3136, v4
    v_add_u32 v66, 2176, v4
    v_add_u32 v67, 1216, v4
    v_add_u32 v68, 4352, v4
    v_add_u32 v69, 3392, v4
    v_add_u32 v70, 2432, v4
    v_add_u32 v71, 1472, v4
    v_add_u32 v72, 4608, v4
    v_add_u32 v73, 3648, v4
    s_add_u32 s96, s12, 4294963200
    s_addc_u32 s97, s13, -1
    s_and_b32 s97, s97, 0xffff
    s_mov_b32 s98, 4722688
    s_mov_b32 s99, 0x20000
    s_mul_i32 s56, s44, 2304
    s_add_u32 s57, s56, 147456
    s_add_u32 s58, s56, 576
    s_add_u32 s59, s56, 148032
    s_add_u32 s60, s56, 1152
    s_add_u32 s61, s56, 148608
    s_add_u32 s62, s56, 1728
    s_add_u32 s63, s56, 149184
    s_lshl_b32 s68, s47, 20
    v_mov_b32 v5, 0x7ff00000
    v_lshrrev_b32 v3, 5, v2
    v_add_u32 v3, 0, v3
    v_add_u32 v3, s52, v3
    v_subrev_u32 v3, 1, v3
    v_and_b32 v4, 31, v2
    v_lshlrev_b32 v4, 4, v4
    v_lshl_add_u32 v4, v3, 9, v4
    v_add_u32 v4, s68, v4
    v_cmp_gt_u32 vcc, 32, v3
    s_nop 1
    v_cndmask_b32 v16, v5, v4, vcc
    v_add_u32 v17, 15360, v16
    v_add_u32 v18, 30720, v16
    v_add_u32 v19, 46080, v16
    v_lshrrev_b32 v3, 5, v2
    v_add_u32 v3, 2, v3
    v_add_u32 v3, s52, v3
    v_subrev_u32 v3, 1, v3
    v_and_b32 v4, 31, v2
    v_lshlrev_b32 v4, 4, v4
    v_lshl_add_u32 v4, v3, 9, v4
    v_add_u32 v4, s68, v4
    v_cmp_gt_u32 vcc, 32, v3
    s_nop 1
    v_cndmask_b32 v20, v5, v4, vcc
    v_add_u32 v21, 15360, v20
    v_add_u32 v22, 30720, v20
    v_add_u32 v23, 46080, v20
    v_lshrrev_b32 v3, 5, v2
    v_add_u32 v3, 4, v3
    v_add_u32 v3, s52, v3
    v_subrev_u32 v3, 1, v3
    v_and_b32 v4, 31, v2
    v_lshlrev_b32 v4, 4, v4
    v_lshl_add_u32 v4, v3, 9, v4
    v_add_u32 v4, s68, v4
    v_cmp_gt_u32 vcc, 32, v3
    s_nop 1
    v_cndmask_b32 v24, v5, v4, vcc
    v_add_u32 v25, 15360, v24
    v_add_u32 v26, 30720, v24
    v_add_u32 v27, 46080, v24
    v_and_b32 v3, 15, v2
    v_lshrrev_b32 v4, 4, v2
    s_add_u32 s68, s53, 20480
    v_lshlrev_b32 v28, 10, v4
    v_lshl_add_u32 v28, v3, 4, v28
    v_add_u32 v28, s68, v28
    v_mov_b32 v5, 163840
    v_subrev_u32 v6, 16, v28
    v_cmp_eq_u32 vcc, 0, v3
    s_nop 1
    v_cndmask_b32 v29, v6, v5, vcc
    v_cmp_eq_u32 vcc, 15, v3
    s_nop 1
    v_cndmask_b32 v30, v28, v5, vcc
    v_add_u32 v51, s68, v31
    v_bfe_u32 v6, v3, 3, 1
    v_lshlrev_b32 v6, 1, v6
    v_mul_u32_u24 v5, 9, v4
    v_lshlrev_b32 v7, 6, v3
    v_add_u32 v7, s53, v7
    v_mov_b32 v10, 0
    v_mov_b32 v11, 9216
    v_cmp_eq_u32 vcc, 0, v4
    s_nop 1
    v_cndmask_b32 v10, v10, v11, vcc
    v_add_u32 v8, 0, v5
    v_lshrrev_b32 v9, 2, v8
    v_and_b32 v8, 3, v8
    v_xor_b32 v8, v8, v6
    v_lshl_add_u32 v74, v9, 10, v7
    v_lshl_add_u32 v74, v8, 4, v74
    v_add_u32 v78, v74, v10
    v_add_u32 v8, 1, v5
    v_lshrrev_b32 v9, 2, v8
    v_and_b32 v8, 3, v8
    v_xor_b32 v8, v8, v6
    v_lshl_add_u32 v75, v9, 10, v7
    v_lshl_add_u32 v75, v8, 4, v75
    v_add_u32 v79, v75, v10
    v_add_u32 v8, 2, v5
    v_lshrrev_b32 v9, 2, v8
    v_and_b32 v8, 3, v8
    v_xor_b32 v8, v8, v6
    v_lshl_add_u32 v76, v9, 10, v7
    v_lshl_add_u32 v76, v8, 4, v76
    v_add_u32 v80, v76, v10
    v_add_u32 v8, 3, v5
    v_lshrrev_b32 v9, 2, v8
    v_and_b32 v8, 3, v8
    v_xor_b32 v8, v8, v6
    v_lshl_add_u32 v77, v9, 10, v7
    v_lshl_add_u32 v77, v8, 4, v77
    v_add_u32 v81, v77, v10
    s_mov_b32 s55, 0xffff
    v_lshlrev_b32 v5, 3, v4
    s_lshl_b32 s68, s51, 1
    s_mov_b32 s36, s16
    s_and_b32 s37, s17, 0xffff
    s_mov_b32 s38, 1024
    s_mov_b32 s39, 0x20000
    buffer_load_dwordx2 v[40:41], v5, s[36:39], s68 offen offset:0
    buffer_load_dwordx2 v[42:43], v5, s[36:39], s68 offen offset:32
    s_mov_b32 s36, s18
    s_and_b32 s37, s19, 0xffff
    s_mov_b32 s38, 1024
    s_mov_b32 s39, 0x20000
    buffer_load_dwordx2 v[44:45], v5, s[36:39], s68 offen offset:0
    buffer_load_dwordx2 v[46:47], v5, s[36:39], s68 offen offset:32
    s_lshl_b32 s64, s44, 18
    s_add_u32 s65, s64, 65536
    s_add_u32 s66, s64, 131072
    s_add_u32 s67, s64, 196608
    s_lshl_b32 s68, s47, 2
    s_add_u32 s68, s68, s44
    s_lshl_b32 s68, s68, 5
    v_lshlrev_b32 v6, 1, v3
    v_add_u32 v49, s68, v6
    v_and_b32 v5, 31, v2
    v_lshrrev_b32 v6, 2, v5
    v_subrev_u32 v7, s50, v6
    v_add_u32 v7, 1, v7
    v_mov_b32 v8, s50
    v_cmp_gt_u32 vcc, 3, v7
    s_nop 1
    v_cndmask_b32 v6, v8, v6, vcc
    v_and_b32 v7, 3, v5
    v_lshl_add_u32 v6, v6, 2, v7
    v_add_u32 v6, s68, v6
    v_lshlrev_b32 v50, 7, v6
    s_lshl_b32 s69, s45, 5
    s_lshl_b32 s70, s49, 1
    s_add_u32 s69, s69, s70
    s_add_u32 s69, s69, 1
    v_and_b32 v6, 3, v2
    v_lshlrev_b32 v6, 3, v6
    v_add_u32 v6, s69, v6
    v_lshlrev_b32 v54, 7, v6
    v_lshlrev_b32 v6, 6, v2
    v_mov_b32 v7, 0x7ff00000
    v_cmp_gt_u32 vcc, 18, v2
    s_nop 1
    v_cndmask_b32 v55, v7, v6, vcc
    v_lshlrev_b32 v49, 7, v49
    s_waitcnt lgkmcnt(0)
    s_lshl_b32 s86, s72, 16
    s_lshl_b32 s87, s76, 16
    v_mov_b32 v190, s86
    v_mov_b32 v198, s87
    s_and_b32 s86, s72, 0xffff0000
    s_and_b32 s87, s76, 0xffff0000
    v_mov_b32 v191, s86
    v_mov_b32 v199, s87
    s_lshl_b32 s86, s73, 16
    s_lshl_b32 s87, s77, 16
    v_mov_b32 v192, s86
    v_mov_b32 v200, s87
    s_and_b32 s86, s73, 0xffff0000
    s_and_b32 s87, s77, 0xffff0000
    v_mov_b32 v193, s86
    v_mov_b32 v201, s87
    s_lshl_b32 s86, s74, 16
    s_lshl_b32 s87, s78, 16
    v_mov_b32 v194, s86
    v_mov_b32 v202, s87
    s_and_b32 s86, s74, 0xffff0000
    s_and_b32 s87, s78, 0xffff0000
    v_mov_b32 v195, s86
    v_mov_b32 v203, s87
    s_lshl_b32 s86, s75, 16
    s_lshl_b32 s87, s79, 16
    v_mov_b32 v196, s86
    v_mov_b32 v204, s87
    s_and_b32 s86, s75, 0xffff0000
    s_and_b32 s87, s79, 0xffff0000
    v_mov_b32 v197, s86
    v_mov_b32 v205, s87
    v_mov_b32 v13, 0
    v_mov_b32 v248, 0
    v_mov_b32 v249, 0
    v_mov_b32 v250, 0
    buffer_load_dword v248, v13, s[40:43], 0 offen sc1
    s_waitcnt vmcnt(1)
L_stat:
    v_lshlrev_b32 v216, 16, v216
    v_lshlrev_b32 v217, 16, v217
    v_lshlrev_b32 v218, 16, v218
    v_lshlrev_b32 v219, 16, v219
    v_lshlrev_b32 v220, 16, v220
    v_lshlrev_b32 v221, 16, v221
    v_lshlrev_b32 v222, 16, v222
    v_lshlrev_b32 v223, 16, v223
    v_lshlrev_b32 v224, 16, v224
    v_lshlrev_b32 v225, 16, v225
    v_lshlrev_b32 v226, 16, v226
    v_lshlrev_b32 v227, 16, v227
    v_lshlrev_b32 v228, 16, v228
    v_lshlrev_b32 v229, 16, v229
    v_lshlrev_b32 v230, 16, v230
    v_lshlrev_b32 v231, 16, v231
    v_lshlrev_b32 v232, 16, v232
    v_lshlrev_b32 v233, 16, v233
    v_lshlrev_b32 v234, 16, v234
    v_lshlrev_b32 v235, 16, v235
    v_lshlrev_b32 v236, 16, v236
    v_lshlrev_b32 v237, 16, v237
    v_lshlrev_b32 v238, 16, v238
    v_lshlrev_b32 v239, 16, v239
    v_lshlrev_b32 v240, 16, v240
    v_lshlrev_b32 v241, 16, v241
    v_lshlrev_b32 v242, 16, v242
    v_lshlrev_b32 v243, 16, v243
    v_lshlrev_b32 v244, 16, v244
    v_lshlrev_b32 v245, 16, v245
    v_lshlrev_b32 v246, 16, v246
    v_lshlrev_b32 v247, 16, v247
    v_pk_add_f32 v[8:9], v[216:217], v[218:219]
    v_pk_mul_f32 v[10:11], v[216:217], v[216:217]
    v_pk_fma_f32 v[10:11], v[218:219], v[218:219], v[10:11]
    v_pk_add_f32 v[8:9], v[8:9], v[220:221]
    v_pk_fma_f32 v[10:11], v[220:221], v[220:221], v[10:11]
    v_pk_add_f32 v[8:9], v[8:9], v[222:223]
    v_pk_fma_f32 v[10:11], v[222:223], v[222:223], v[10:11]
    v_pk_add_f32 v[8:9], v[8:9], v[224:225]
    v_pk_fma_f32 v[10:11], v[224:225], v[224:225], v[10:11]
    v_pk_add_f32 v[8:9], v[8:9], v[226:227]
    v_pk_fma_f32 v[10:11], v[226:227], v[226:227], v[10:11]
    v_pk_add_f32 v[8:9], v[8:9], v[228:229]
    v_pk_fma_f32 v[10:11], v[228:229], v[228:229], v[10:11]
    v_pk_add_f32 v[8:9], v[8:9], v[230:231]
    v_pk_fma_f32 v[10:11], v[230:231], v[230:231], v[10:11]
    v_pk_add_f32 v[8:9], v[8:9], v[232:233]
    v_pk_fma_f32 v[10:11], v[232:233], v[232:233], v[10:11]
    v_pk_add_f32 v[8:9], v[8:9], v[234:235]
    v_pk_fma_f32 v[10:11], v[234:235], v[234:235], v[10:11]
    v_pk_add_f32 v[8:9], v[8:9], v[236:237]
    v_pk_fma_f32 v[10:11], v[236:237], v[236:237], v[10:11]
    v_pk_add_f32 v[8:9], v[8:9], v[238:239]
    v_pk_fma_f32 v[10:11], v[238:239], v[238:239], v[10:11]
    v_pk_add_f32 v[8:9], v[8:9], v[240:241]
    v_pk_fma_f32 v[10:11], v[240:241], v[240:241], v[10:11]
    v_pk_add_f32 v[8:9], v[8:9], v[242:243]
    v_pk_fma_f32 v[10:11], v[242:243], v[242:243], v[10:11]
    v_pk_add_f32 v[8:9], v[8:9], v[244:245]
    v_pk_fma_f32 v[10:11], v[244:245], v[244:245], v[10:11]
    v_pk_add_f32 v[8:9], v[8:9], v[246:247]
    v_pk_fma_f32 v[10:11], v[246:247], v[246:247], v[10:11]
    v_add_f32 v8, v8, v9
    v_add_f32 v9, v10, v11
    s_nop 0
    s_nop 0
    v_add_f32_dpp v8, v8, v8 quad_perm:[1,0,3,2] row_mask:0xf bank_mask:0xf
    v_add_f32_dpp v9, v9, v9 quad_perm:[1,0,3,2] row_mask:0xf bank_mask:0xf
    s_nop 0
    v_add_f32_dpp v8, v8, v8 quad_perm:[2,3,0,1] row_mask:0xf bank_mask:0xf
    v_add_f32_dpp v9, v9, v9 quad_perm:[2,3,0,1] row_mask:0xf bank_mask:0xf
    s_nop 0
    v_add_f32_dpp v8, v8, v8 row_half_mirror row_mask:0xf bank_mask:0xf
    v_add_f32_dpp v9, v9, v9 row_half_mirror row_mask:0xf bank_mask:0xf
    s_nop 0
    v_add_f32_dpp v8, v8, v8 row_mirror row_mask:0xf bank_mask:0xf
    v_add_f32_dpp v9, v9, v9 row_mirror row_mask:0xf bank_mask:0xf
    s_nop 0
    v_add_f32_dpp v8, v8, v8 row_bcast:15 row_mask:0xa bank_mask:0xf
    v_add_f32_dpp v9, v9, v9 row_bcast:15 row_mask:0xa bank_mask:0xf
    s_nop 0
    v_add_f32_dpp v8, v8, v8 row_bcast:31 row_mask:0xc bank_mask:0xf
    v_add_f32_dpp v9, v9, v9 row_bcast:31 row_mask:0xc bank_mask:0xf
    v_readlane_b32 s86, v8, 63
    s_nop 0
    v_readlane_b32 s87, v9, 63
    s_waitcnt vmcnt(0)
    v_or3_b32 v12, v248, v249, v250
    v_mov_b32 v4, s86
    v_mov_b32 v6, s87
    v_mov_b32 v13, 0
    s_mov_b32 s69, 0
L_ep:
    v_readfirstlane_b32 s54, v12
    s_add_u32 s69, s69, 1
    s_cmp_lg_u32 s54, 0
    s_cbranch_scc1 L_epok
    s_cmp_gt_u32 s69, 0x40000
    s_cbranch_scc1 L_epok
    buffer_load_dword v12, v13, s[40:43], 0 offen sc1
    s_waitcnt vmcnt(0)
    s_branch L_ep
L_epok:
    v_mov_b32 v5, v12
    v_mov_b32 v7, v12
    s_lshl_b32 s74, s85, 2
    s_add_u32 s74, s74, s44
    s_lshl_b32 s70, s74, 4
    s_add_u32 s70, s70, 7471104
    s_lshl_b32 s71, s74, 7
    s_add_u32 s71, s71, 7536640
    v_mov_b32 v13, 0
    v_cmp_eq_u32 vcc, 0, v2
    s_and_saveexec_b64 s[90:91], vcc
    buffer_store_dwordx4 v[4:7], v13, s[28:31], s70 offen
    s_mov_b64 exec, s[90:91]
    v_and_b32 v12, 63, v2
    v_lshlrev_b32 v12, 4, v12
    s_lshl_b32 s68, s45, 10
    s_add_u32 s68, s68, 7471104
    s_mov_b32 s69, 0
    s_movk_i32 s72, 1024
L_p1:
    buffer_load_dwordx4 v[8:11], v12, s[28:31], s68 offen sc1
    s_waitcnt vmcnt(0)
    v_xor_b32 v13, s54, v9
    v_xor_b32 v14, s54, v11
    v_or_b32 v13, v13, v14
    v_cmp_eq_u32 vcc, 0, v13
    s_add_u32 s69, s69, 1
    s_cmp_eq_u64 vcc, exec
    s_cbranch_scc1 L_p1_ok
    s_cmp_lg_u32 s69, 2
    s_cbranch_scc1 L_p1_c1
    v_mov_b32 v13, 0
    v_cmp_eq_u32 vcc, 0, v2
    s_and_saveexec_b64 s[90:91], vcc
    buffer_store_dwordx4 v[4:7], v13, s[28:31], s71 offen sc1
    s_mov_b64 exec, s[90:91]
L_p1_c1:
    s_cmp_lg_u32 s69, 12
    s_cbranch_scc1 L_p1_c2
    v_lshlrev_b32 v12, 3, v12
    s_movk_i32 s72, 8192
    s_lshl_b32 s68, s45, 13
    s_add_u32 s68, s68, 7536640
L_p1_c2:
    s_cmp_lt_u32 s69, 0x40000
    s_cbranch_scc1 L_p1
L_p1_ok:
    s_cmp_gt_u32 s69, 2
    s_cbranch_scc1 L_p1_c3
    v_mov_b32 v13, 0
    v_cmp_eq_u32 vcc, 0, v2
    s_and_saveexec_b64 s[90:91], vcc
    buffer_store_dwordx4 v[4:7], v13, s[28:31], s71 offen sc1
    s_mov_b64 exec, s[90:91]
L_p1_c3:
    s_nop 0
    v_add_f32_dpp v8, v8, v8 quad_perm:[1,0,3,2] row_mask:0xf bank_mask:0xf
    v_add_f32_dpp v10, v10, v10 quad_perm:[1,0,3,2] row_mask:0xf bank_mask:0xf
    s_nop 0
    v_add_f32_dpp v8, v8, v8 quad_perm:[2,3,0,1] row_mask:0xf bank_mask:0xf
    v_add_f32_dpp v10, v10, v10 quad_perm:[2,3,0,1] row_mask:0xf bank_mask:0xf
    s_nop 0
    v_add_f32_dpp v8, v8, v8 row_half_mirror row_mask:0xf bank_mask:0xf
    v_add_f32_dpp v10, v10, v10 row_half_mirror row_mask:0xf bank_mask:0xf
    s_nop 0
    v_add_f32_dpp v8, v8, v8 row_mirror row_mask:0xf bank_mask:0xf
    v_add_f32_dpp v10, v10, v10 row_mirror row_mask:0xf bank_mask:0xf
    s_nop 0
    v_add_f32_dpp v8, v8, v8 row_bcast:15 row_mask:0xa bank_mask:0xf
    v_add_f32_dpp v10, v10, v10 row_bcast:15 row_mask:0xa bank_mask:0xf
    s_nop 0
    v_add_f32_dpp v8, v8, v8 row_bcast:31 row_mask:0xc bank_mask:0xf
    v_add_f32_dpp v10, v10, v10 row_bcast:31 row_mask:0xc bank_mask:0xf
    v_readlane_b32 s86, v8, 63
    s_nop 0
    v_readlane_b32 s87, v10, 63
    v_mov_b32 v8, 0x37000000
    s_nop 0
    v_mul_f32 v10, s87, v8
    v_mul_f32 v8, s86, v8
    v_fma_f32 v10, -v8, v8, v10
    v_max_f32 v10, 0, v10
    v_add_f32 v10, 0x3727c5ac, v10
    v_rsq_f32 v10, v10
    v_sub_f32 v8, 0, v8
    v_mov_b32 v9, v8
    v_mov_b32 v11, v10
    v_pk_mul_f32 v[190:191], v[190:191], v[10:11]
    v_pk_fma_f32 v[198:199], v[190:191], v[8:9], v[198:199]
    v_pk_mul_f32 v[192:193], v[192:193], v[10:11]
    v_pk_fma_f32 v[200:201], v[192:193], v[8:9], v[200:201]
    v_pk_mul_f32 v[194:195], v[194:195], v[10:11]
    v_pk_fma_f32 v[202:203], v[194:195], v[8:9], v[202:203]
    v_pk_mul_f32 v[196:197], v[196:197], v[10:11]
    v_pk_fma_f32 v[204:205], v[196:197], v[8:9], v[204:205]
    v_pk_fma_f32 v[216:217], v[216:217], v[190:191], v[198:199]
    v_pk_fma_f32 v[218:219], v[218:219], v[192:193], v[200:201]
    v_pk_fma_f32 v[220:221], v[220:221], v[194:195], v[202:203]
    v_pk_fma_f32 v[222:223], v[222:223], v[196:197], v[204:205]
    v_pk_mul_f32 v[206:207], v[216:217], s[80:81]
    v_pk_mul_f32 v[208:209], v[218:219], s[80:81]
    v_pk_mul_f32 v[210:211], v[220:221], s[80:81]
    v_pk_mul_f32 v[212:213], v[222:223], s[80:81]
    v_exp_f32 v206, v206
    v_exp_f32 v207, v207
    v_exp_f32 v208, v208
    v_exp_f32 v209, v209
    v_exp_f32 v210, v210
    v_exp_f32 v211, v211
    v_exp_f32 v212, v212
    v_exp_f32 v213, v213
    v_pk_add_f32 v[206:207], v[206:207], s[82:83]
    v_pk_add_f32 v[208:209], v[208:209], s[82:83]
    v_pk_add_f32 v[210:211], v[210:211], s[82:83]
    v_pk_add_f32 v[212:213], v[212:213], s[82:83]
    v_rcp_f32 v206, v206
    v_rcp_f32 v207, v207
    v_rcp_f32 v208, v208
    v_rcp_f32 v209, v209
    v_rcp_f32 v210, v210
    v_rcp_f32 v211, v211
    v_rcp_f32 v212, v212
    v_rcp_f32 v213, v213
    v_pk_mul_f32 v[216:217], v[216:217], v[206:207]
    v_pk_mul_f32 v[218:219], v[218:219], v[208:209]
    v_pk_mul_f32 v[220:221], v[220:221], v[210:211]
    v_pk_mul_f32 v[222:223], v[222:223], v[212:213]
    v_cvt_pk_bf16_f32 v216, v216, v217
    v_cvt_pk_bf16_f32 v217, v218, v219
    v_cvt_pk_bf16_f32 v218, v220, v221
    v_cvt_pk_bf16_f32 v219, v222, v223
    buffer_store_dwordx4 v[216:219], v31, s[28:31], s88 offen offset:0 sc1
    v_pk_fma_f32 v[224:225], v[224:225], v[190:191], v[198:199]
    v_pk_fma_f32 v[226:227], v[226:227], v[192:193], v[200:201]
    v_pk_fma_f32 v[228:229], v[228:229], v[194:195], v[202:203]
    v_pk_fma_f32 v[230:231], v[230:231], v[196:197], v[204:205]
    v_pk_mul_f32 v[206:207], v[224:225], s[80:81]
    v_pk_mul_f32 v[208:209], v[226:227], s[80:81]
    v_pk_mul_f32 v[210:211], v[228:229], s[80:81]
    v_pk_mul_f32 v[212:213], v[230:231], s[80:81]
    v_exp_f32 v206, v206
    v_exp_f32 v207, v207
    v_exp_f32 v208, v208
    v_exp_f32 v209, v209
    v_exp_f32 v210, v210
    v_exp_f32 v211, v211
    v_exp_f32 v212, v212
    v_exp_f32 v213, v213
    v_pk_add_f32 v[206:207], v[206:207], s[82:83]
    v_pk_add_f32 v[208:209], v[208:209], s[82:83]
    v_pk_add_f32 v[210:211], v[210:211], s[82:83]
    v_pk_add_f32 v[212:213], v[212:213], s[82:83]
    v_rcp_f32 v206, v206
    v_rcp_f32 v207, v207
    v_rcp_f32 v208, v208
    v_rcp_f32 v209, v209
    v_rcp_f32 v210, v210
    v_rcp_f32 v211, v211
    v_rcp_f32 v212, v212
    v_rcp_f32 v213, v213
    v_pk_mul_f32 v[224:225], v[224:225], v[206:207]
    v_pk_mul_f32 v[226:227], v[226:227], v[208:209]
    v_pk_mul_f32 v[228:229], v[228:229], v[210:211]
    v_pk_mul_f32 v[230:231], v[230:231], v[212:213]
    v_cvt_pk_bf16_f32 v224, v224, v225
    v_cvt_pk_bf16_f32 v225, v226, v227
    v_cvt_pk_bf16_f32 v226, v228, v229
    v_cvt_pk_bf16_f32 v227, v230, v231
    buffer_store_dwordx4 v[224:227], v31, s[28:31], s88 offen offset:1024 sc1
    v_pk_fma_f32 v[232:233], v[232:233], v[190:191], v[198:199]
    v_pk_fma_f32 v[234:235], v[234:235], v[192:193], v[200:201]
    v_pk_fma_f32 v[236:237], v[236:237], v[194:195], v[202:203]
    v_pk_fma_f32 v[238:239], v[238:239], v[196:197], v[204:205]
    v_pk_mul_f32 v[206:207], v[232:233], s[80:81]
    v_pk_mul_f32 v[208:209], v[234:235], s[80:81]
    v_pk_mul_f32 v[210:211], v[236:237], s[80:81]
    v_pk_mul_f32 v[212:213], v[238:239], s[80:81]
    v_exp_f32 v206, v206
    v_exp_f32 v207, v207
    v_exp_f32 v208, v208
    v_exp_f32 v209, v209
    v_exp_f32 v210, v210
    v_exp_f32 v211, v211
    v_exp_f32 v212, v212
    v_exp_f32 v213, v213
    v_pk_add_f32 v[206:207], v[206:207], s[82:83]
    v_pk_add_f32 v[208:209], v[208:209], s[82:83]
    v_pk_add_f32 v[210:211], v[210:211], s[82:83]
    v_pk_add_f32 v[212:213], v[212:213], s[82:83]
    v_rcp_f32 v206, v206
    v_rcp_f32 v207, v207
    v_rcp_f32 v208, v208
    v_rcp_f32 v209, v209
    v_rcp_f32 v210, v210
    v_rcp_f32 v211, v211
    v_rcp_f32 v212, v212
    v_rcp_f32 v213, v213
    v_pk_mul_f32 v[232:233], v[232:233], v[206:207]
    v_pk_mul_f32 v[234:235], v[234:235], v[208:209]
    v_pk_mul_f32 v[236:237], v[236:237], v[210:211]
    v_pk_mul_f32 v[238:239], v[238:239], v[212:213]
    v_cvt_pk_bf16_f32 v232, v232, v233
    v_cvt_pk_bf16_f32 v233, v234, v235
    v_cvt_pk_bf16_f32 v234, v236, v237
    v_cvt_pk_bf16_f32 v235, v238, v239
    buffer_store_dwordx4 v[232:235], v31, s[28:31], s88 offen offset:2048 sc1
    v_pk_fma_f32 v[240:241], v[240:241], v[190:191], v[198:199]
    v_pk_fma_f32 v[242:243], v[242:243], v[192:193], v[200:201]
    v_pk_fma_f32 v[244:245], v[244:245], v[194:195], v[202:203]
    v_pk_fma_f32 v[246:247], v[246:247], v[196:197], v[204:205]
    v_pk_mul_f32 v[206:207], v[240:241], s[80:81]
    v_pk_mul_f32 v[208:209], v[242:243], s[80:81]
    v_pk_mul_f32 v[210:211], v[244:245], s[80:81]
    v_pk_mul_f32 v[212:213], v[246:247], s[80:81]
    v_exp_f32 v206, v206
    v_exp_f32 v207, v207
    v_exp_f32 v208, v208
    v_exp_f32 v209, v209
    v_exp_f32 v210, v210
    v_exp_f32 v211, v211
    v_exp_f32 v212, v212
    v_exp_f32 v213, v213
    v_pk_add_f32 v[206:207], v[206:207], s[82:83]
    v_pk_add_f32 v[208:209], v[208:209], s[82:83]
    v_pk_add_f32 v[210:211], v[210:211], s[82:83]
    v_pk_add_f32 v[212:213], v[212:213], s[82:83]
    v_rcp_f32 v206, v206
    v_rcp_f32 v207, v207
    v_rcp_f32 v208, v208
    v_rcp_f32 v209, v209
    v_rcp_f32 v210, v210
    v_rcp_f32 v211, v211
    v_rcp_f32 v212, v212
    v_rcp_f32 v213, v213
    v_pk_mul_f32 v[240:241], v[240:241], v[206:207]
    v_pk_mul_f32 v[242:243], v[242:243], v[208:209]
    v_pk_mul_f32 v[244:245], v[244:245], v[210:211]
    v_pk_mul_f32 v[246:247], v[246:247], v[212:213]
    v_cvt_pk_bf16_f32 v240, v240, v241
    v_cvt_pk_bf16_f32 v241, v242, v243
    v_cvt_pk_bf16_f32 v242, v244, v245
    v_cvt_pk_bf16_f32 v243, v246, v247
    buffer_store_dwordx4 v[240:243], v31, s[28:31], s88 offen offset:3072 sc1
    s_branch L_join
L_warm:
    s_lshr_b32 s76, s46, 1
    s_and_b32 s77, s76, 3
    s_lshr_b32 s78, s76, 2
    v_and_b32 v5, 3, v2
    v_lshlrev_b32 v6, 21, v5
    v_and_b32 v5, 1, v5
    v_mul_u32_u24 v5, 0x1f0000, v5
    v_add_u32 v5, v5, v6
    buffer_load_dword v220, v5, s[28:31], 0 offen sc1
    v_mov_b32 v5, 0
    s_mov_b32 s36, s22
    s_and_b32 s37, s23, 0xffff
    s_mov_b32 s38, 2097152
    s_mov_b32 s39, 0x20000
    buffer_load_dword v220, v5, s[36:39], 0 offen sc1
    s_and_b32 s68, s84, 0xfe
    s_lshl_b32 s68, s68, 7
    s_add_u32 s68, s68, 7864320
    v_and_b32 v5, 1, v2
    v_lshlrev_b32 v5, 7, v5
    v_bfe_u32 v6, v2, 1, 1
    v_mul_u32_u24 v6, 131072, v6
    v_add_u32 v5, v5, v6
    buffer_load_dword v220, v5, s[28:31], s68 offen sc1
    s_mov_b32 s36, s14
    s_and_b32 s37, s15, 0xffff
    s_mov_b32 s38, 786432
    s_mov_b32 s39, 0x20000
    v_lshrrev_b32 v6, 2, v0
    v_and_b32 v5, 3, v0
    v_lshlrev_b32 v7, 10, v6
    v_lshl_add_u32 v7, v5, 4, v7
    s_mul_i32 s68, s78, 196608
    s_lshl_b32 s69, s48, 8
    s_add_u32 s68, s68, s69
    s_lshl_b32 s69, s77, 6
    s_add_u32 s68, s68, s69
    buffer_load_dwordx4 v[118:121], v7, s[36:39], s68 offen
    s_add_u32 s68, s68, 65536
    buffer_load_dwordx4 v[122:125], v7, s[36:39], s68 offen
    s_add_u32 s68, s68, 65536
    buffer_load_dwordx4 v[126:129], v7, s[36:39], s68 offen
    s_mov_b32 s36, s6
    s_and_b32 s37, s7, 0xffff
    s_mov_b32 s38, 3072
    s_mov_b32 s39, 0x20000
    v_lshlrev_b32 v7, 1, v6
    s_mul_i32 s68, s47, 1536
    s_mul_i32 s69, s78, 384
    s_add_u32 s68, s68, s69
    buffer_load_ushort v130, v7, s[36:39], s68 offen offset:0
    buffer_load_ushort v131, v7, s[36:39], s68 offen offset:128
    buffer_load_ushort v132, v7, s[36:39], s68 offen offset:256
    v_mov_b32 v133, 0
    s_mov_b32 s36, s12
    s_and_b32 s37, s13, 0xffff
    s_mov_b32 s38, 4718592
    s_mov_b32 s39, 0x20000
    s_lshl_b32 s68, s48, 6
    s_lshl_b32 s69, s76, 2
    s_add_u32 s68, s68, s69
    s_add_u32 s68, s68, s44
    s_mul_i32 s68, s68, 18432
    v_lshlrev_b32 v8, 7, v2
    v_mov_b32 v9, 0x7ff00000
    v_cmp_gt_u32 vcc, 16, v2
    s_nop 1
    v_cndmask_b32 v9, v9, v8, vcc
    buffer_load_dword v216, v8, s[36:39], s68 offen
    s_add_u32 s68, s68, 8192
    buffer_load_dword v216, v8, s[36:39], s68 offen
    s_add_u32 s68, s68, 8192
    buffer_load_dword v216, v9, s[36:39], s68 offen
    s_mov_b32 s36, s20
    s_and_b32 s37, s21, 0xffff
    s_mov_b32 s38, 4718592
    s_mov_b32 s39, 0x20000
    s_lshl_b32 s68, s48, 7
    s_lshl_b32 s69, s76, 2
    s_add_u32 s68, s68, s69
    s_add_u32 s68, s68, s44
    s_lshl_b32 s69, s47, 6
    s_add_u32 s68, s68, s69
    s_mul_i32 s68, s68, 9216
    v_lshlrev_b32 v8, 7, v2
    v_mov_b32 v9, 0x7ff00000
    v_cmp_gt_u32 vcc, 8, v2
    s_nop 1
    v_cndmask_b32 v9, v9, v8, vcc
    buffer_load_dword v216, v8, s[36:39], s68 offen
    s_add_u32 s68, s68, 8192
    buffer_load_dword v216, v9, s[36:39], s68 offen
    v_lshrrev_b32 v4, 2, v2
    v_and_b32 v5, 3, v2
    v_bfe_u32 v6, v4, 3, 1
    v_lshlrev_b32 v6, 1, v6
    v_xor_b32 v5, v5, v6
    s_movk_i32 s68, 9216
    v_add_u32 v4, s51, v4
    v_mul_u32_u24 v4, s68, v4
    v_lshl_add_u32 v4, v5, 4, v4
    v_add_u32 v64, 4096, v4
    v_add_u32 v65, 3136, v4
    v_add_u32 v66, 2176, v4
    v_add_u32 v67, 1216, v4
    v_add_u32 v68, 4352, v4
    v_add_u32 v69, 3392, v4
    v_add_u32 v70, 2432, v4
    v_add_u32 v71, 1472, v4
    v_add_u32 v72, 4608, v4
    v_add_u32 v73, 3648, v4
    s_add_u32 s96, s12, 4294963200
    s_addc_u32 s97, s13, -1
    s_and_b32 s97, s97, 0xffff
    s_mov_b32 s98, 4722688
    s_mov_b32 s99, 0x20000
    s_mul_i32 s56, s44, 2304
    s_add_u32 s57, s56, 147456
    s_add_u32 s58, s56, 576
    s_add_u32 s59, s56, 148032
    s_add_u32 s60, s56, 1152
    s_add_u32 s61, s56, 148608
    s_add_u32 s62, s56, 1728
    s_add_u32 s63, s56, 149184
    s_lshl_b32 s68, s47, 20
    v_mov_b32 v5, 0x7ff00000
    v_lshrrev_b32 v3, 5, v2
    v_add_u32 v3, 0, v3
    v_add_u32 v3, s52, v3
    v_subrev_u32 v3, 1, v3
    v_and_b32 v4, 31, v2
    v_lshlrev_b32 v4, 4, v4
    v_lshl_add_u32 v4, v3, 9, v4
    v_add_u32 v4, s68, v4
    v_cmp_gt_u32 vcc, 32, v3
    s_nop 1
    v_cndmask_b32 v16, v5, v4, vcc
    v_add_u32 v17, 15360, v16
    v_add_u32 v18, 30720, v16
    v_add_u32 v19, 46080, v16
    v_lshrrev_b32 v3, 5, v2
    v_add_u32 v3, 2, v3
    v_add_u32 v3, s52, v3
    v_subrev_u32 v3, 1, v3
    v_and_b32 v4, 31, v2
    v_lshlrev_b32 v4, 4, v4
    v_lshl_add_u32 v4, v3, 9, v4
    v_add_u32 v4, s68, v4
    v_cmp_gt_u32 vcc, 32, v3
    s_nop 1
    v_cndmask_b32 v20, v5, v4, vcc
    v_add_u32 v21, 15360, v20
    v_add_u32 v22, 30720, v20
    v_add_u32 v23, 46080, v20
    v_lshrrev_b32 v3, 5, v2
    v_add_u32 v3, 4, v3
    v_add_u32 v3, s52, v3
    v_subrev_u32 v3, 1, v3
    v_and_b32 v4, 31, v2
    v_lshlrev_b32 v4, 4, v4
    v_lshl_add_u32 v4, v3, 9, v4
    v_add_u32 v4, s68, v4
    v_cmp_gt_u32 vcc, 32, v3
    s_nop 1
    v_cndmask_b32 v24, v5, v4, vcc
    v_add_u32 v25, 15360, v24
    v_add_u32 v26, 30720, v24
    v_add_u32 v27, 46080, v24
    v_and_b32 v3, 15, v2
    v_lshrrev_b32 v4, 4, v2
    s_add_u32 s68, s53, 20480
    v_lshlrev_b32 v28, 10, v4
    v_lshl_add_u32 v28, v3, 4, v28
    v_add_u32 v28, s68, v28
    v_mov_b32 v5, 163840
    v_subrev_u32 v6, 16, v28
    v_cmp_eq_u32 vcc, 0, v3
    s_nop 1
    v_cndmask_b32 v29, v6, v5, vcc
    v_cmp_eq_u32 vcc, 15, v3
    s_nop 1
    v_cndmask_b32 v30, v28, v5, vcc
    v_add_u32 v51, s68, v31
    v_bfe_u32 v6, v3, 3, 1
    v_lshlrev_b32 v6, 1, v6
    v_mul_u32_u24 v5, 9, v4
    v_lshlrev_b32 v7, 6, v3
    v_add_u32 v7, s53, v7
    v_mov_b32 v10, 0
    v_mov_b32 v11, 9216
    v_cmp_eq_u32 vcc, 0, v4
    s_nop 1
    v_cndmask_b32 v10, v10, v11, vcc
    v_add_u32 v8, 0, v5
    v_lshrrev_b32 v9, 2, v8
    v_and_b32 v8, 3, v8
    v_xor_b32 v8, v8, v6
    v_lshl_add_u32 v74, v9, 10, v7
    v_lshl_add_u32 v74, v8, 4, v74
    v_add_u32 v78, v74, v10
    v_add_u32 v8, 1, v5
    v_lshrrev_b32 v9, 2, v8
    v_and_b32 v8, 3, v8
    v_xor_b32 v8, v8, v6
    v_lshl_add_u32 v75, v9, 10, v7
    v_lshl_add_u32 v75, v8, 4, v75
    v_add_u32 v79, v75, v10
    v_add_u32 v8, 2, v5
    v_lshrrev_b32 v9, 2, v8
    v_and_b32 v8, 3, v8
    v_xor_b32 v8, v8, v6
    v_lshl_add_u32 v76, v9, 10, v7
    v_lshl_add_u32 v76, v8, 4, v76
    v_add_u32 v80, v76, v10
    v_add_u32 v8, 3, v5
    v_lshrrev_b32 v9, 2, v8
    v_and_b32 v8, 3, v8
    v_xor_b32 v8, v8, v6
    v_lshl_add_u32 v77, v9, 10, v7
    v_lshl_add_u32 v77, v8, 4, v77
    v_add_u32 v81, v77, v10
    s_mov_b32 s55, 0xffff
    v_lshlrev_b32 v5, 3, v4
    s_lshl_b32 s68, s51, 1
    s_mov_b32 s36, s16
    s_and_b32 s37, s17, 0xffff
    s_mov_b32 s38, 1024
    s_mov_b32 s39, 0x20000
    buffer_load_dwordx2 v[40:41], v5, s[36:39], s68 offen offset:0
    buffer_load_dwordx2 v[42:43], v5, s[36:39], s68 offen offset:32
    s_mov_b32 s36, s18
    s_and_b32 s37, s19, 0xffff
    s_mov_b32 s38, 1024
    s_mov_b32 s39, 0x20000
    buffer_load_dwordx2 v[44:45], v5, s[36:39], s68 offen offset:0
    buffer_load_dwordx2 v[46:47], v5, s[36:39], s68 offen offset:32
    s_lshl_b32 s64, s44, 18
    s_add_u32 s65, s64, 65536
    s_add_u32 s66, s64, 131072
    s_add_u32 s67, s64, 196608
    s_lshl_b32 s68, s47, 2
    s_add_u32 s68, s68, s44
    s_lshl_b32 s68, s68, 5
    v_lshlrev_b32 v6, 1, v3
    v_add_u32 v49, s68, v6
    v_and_b32 v5, 31, v2
    v_lshrrev_b32 v6, 2, v5
    v_subrev_u32 v7, s50, v6
    v_add_u32 v7, 1, v7
    v_mov_b32 v8, s50
    v_cmp_gt_u32 vcc, 3, v7
    s_nop 1
    v_cndmask_b32 v6, v8, v6, vcc
    v_and_b32 v7, 3, v5
    v_lshl_add_u32 v6, v6, 2, v7
    v_add_u32 v6, s68, v6
    v_lshlrev_b32 v50, 7, v6
    s_lshl_b32 s69, s45, 5
    s_lshl_b32 s70, s49, 1
    s_add_u32 s69, s69, s70
    s_add_u32 s69, s69, 1
    v_and_b32 v6, 3, v2
    v_lshlrev_b32 v6, 3, v6
    v_add_u32 v6, s69, v6
    v_lshlrev_b32 v54, 7, v6
    v_lshlrev_b32 v6, 6, v2
    v_mov_b32 v7, 0x7ff00000
    v_cmp_gt_u32 vcc, 18, v2
    s_nop 1
    v_cndmask_b32 v55, v7, v6, vcc
    v_lshlrev_b32 v49, 7, v49
    s_waitcnt vmcnt(9)
    v_lshlrev_b32 v130, 16, v130
    v_lshlrev_b32 v131, 16, v131
    v_lshlrev_b32 v132, 16, v132
    v_pk_mul_f32 v[142:143], v[130:131], s[80:81]
    v_pk_mul_f32 v[144:145], v[132:133], s[80:81]
    v_exp_f32 v142, v142
    v_exp_f32 v143, v143
    v_exp_f32 v144, v144
    v_exp_f32 v145, v145
    s_nop 0
    v_pk_add_f32 v[142:143], v[142:143], s[82:83]
    v_pk_add_f32 v[144:145], v[144:145], s[82:83]
    v_rcp_f32 v142, v142
    v_rcp_f32 v143, v143
    v_rcp_f32 v144, v144
    v_rcp_f32 v145, v145
    s_nop 0
    v_pk_mul_f32 v[130:131], v[130:131], v[142:143]
    v_pk_mul_f32 v[132:133], v[132:133], v[144:145]
    v_lshlrev_b32 v4, 16, v118
    v_and_b32 v5, 0xffff0000, v118
    v_mul_f32 v134, v4, v130
    v_mul_f32 v135, v5, v130
    v_lshlrev_b32 v4, 16, v119
    v_and_b32 v5, 0xffff0000, v119
    v_mul_f32 v136, v4, v130
    v_mul_f32 v137, v5, v130
    v_lshlrev_b32 v4, 16, v120
    v_and_b32 v5, 0xffff0000, v120
    v_mul_f32 v138, v4, v130
    v_mul_f32 v139, v5, v130
    v_lshlrev_b32 v4, 16, v121
    v_and_b32 v5, 0xffff0000, v121
    v_mul_f32 v140, v4, v130
    v_mul_f32 v141, v5, v130
    v_lshlrev_b32 v4, 16, v122
    v_and_b32 v5, 0xffff0000, v122
    v_fmac_f32 v134, v4, v131
    v_fmac_f32 v135, v5, v131
    v_lshlrev_b32 v4, 16, v123
    v_and_b32 v5, 0xffff0000, v123
    v_fmac_f32 v136, v4, v131
    v_fmac_f32 v137, v5, v131
    v_lshlrev_b32 v4, 16, v124
    v_and_b32 v5, 0xffff0000, v124
    v_fmac_f32 v138, v4, v131
    v_fmac_f32 v139, v5, v131
    v_lshlrev_b32 v4, 16, v125
    v_and_b32 v5, 0xffff0000, v125
    v_fmac_f32 v140, v4, v131
    v_fmac_f32 v141, v5, v131
    v_lshlrev_b32 v4, 16, v126
    v_and_b32 v5, 0xffff0000, v126
    v_fmac_f32 v134, v4, v132
    v_fmac_f32 v135, v5, v132
    v_lshlrev_b32 v4, 16, v127
    v_and_b32 v5, 0xffff0000, v127
    v_fmac_f32 v136, v4, v132
    v_fmac_f32 v137, v5, v132
    v_lshlrev_b32 v4, 16, v128
    v_and_b32 v5, 0xffff0000, v128
    v_fmac_f32 v138, v4, v132
    v_fmac_f32 v139, v5, v132
    v_lshlrev_b32 v4, 16, v129
    v_and_b32 v5, 0xffff0000, v129
    v_fmac_f32 v140, v4, v132
    v_fmac_f32 v141, v5, v132
    s_nop 1
    v_add_f32_dpp v134, v134, v134 row_ror:4 row_mask:0xf bank_mask:0xf
    v_add_f32_dpp v135, v135, v135 row_ror:4 row_mask:0xf bank_mask:0xf
    v_add_f32_dpp v136, v136, v136 row_ror:4 row_mask:0xf bank_mask:0xf
    v_add_f32_dpp v137, v137, v137 row_ror:4 row_mask:0xf bank_mask:0xf
    v_add_f32_dpp v138, v138, v138 row_ror:4 row_mask:0xf bank_mask:0xf
    v_add_f32_dpp v139, v139, v139 row_ror:4 row_mask:0xf bank_mask:0xf
    v_add_f32_dpp v140, v140, v140 row_ror:4 row_mask:0xf bank_mask:0xf
    v_add_f32_dpp v141, v141, v141 row_ror:4 row_mask:0xf bank_mask:0xf
    s_nop 1
    v_add_f32_dpp v134, v134, v134 row_ror:8 row_mask:0xf bank_mask:0xf
    v_add_f32_dpp v135, v135, v135 row_ror:8 row_mask:0xf bank_mask:0xf
    v_add_f32_dpp v136, v136, v136 row_ror:8 row_mask:0xf bank_mask:0xf
    v_add_f32_dpp v137, v137, v137 row_ror:8 row_mask:0xf bank_mask:0xf
    v_add_f32_dpp v138, v138, v138 row_ror:8 row_mask:0xf bank_mask:0xf
    v_add_f32_dpp v139, v139, v139 row_ror:8 row_mask:0xf bank_mask:0xf
    v_add_f32_dpp v140, v140, v140 row_ror:8 row_mask:0xf bank_mask:0xf
    v_add_f32_dpp v141, v141, v141 row_ror:8 row_mask:0xf bank_mask:0xf
    v_mov_b32 v142, v134
    v_mov_b32 v143, v135
    v_mov_b32 v144, v136
    v_mov_b32 v145, v137
    v_mov_b32 v146, v138
    v_mov_b32 v147, v139
    v_mov_b32 v148, v140
    v_mov_b32 v149, v141
    s_nop 1
    v_permlane16_swap_b32 v134, v142
    v_permlane16_swap_b32 v135, v143
    v_permlane16_swap_b32 v136, v144
    v_permlane16_swap_b32 v137, v145
    v_permlane16_swap_b32 v138, v146
    v_permlane16_swap_b32 v139, v147
    v_permlane16_swap_b32 v140, v148
    v_permlane16_swap_b32 v141, v149
    s_nop 1
    v_add_f32 v134, v134, v142
    v_add_f32 v135, v135, v143
    v_add_f32 v136, v136, v144
    v_add_f32 v137, v137, v145
    v_add_f32 v138, v138, v146
    v_add_f32 v139, v139, v147
    v_add_f32 v140, v140, v148
    v_add_f32 v141, v141, v149
    v_mov_b32 v142, v134
    v_mov_b32 v143, v135
    v_mov_b32 v144, v136
    v_mov_b32 v145, v137
    v_mov_b32 v146, v138
    v_mov_b32 v147, v139
    v_mov_b32 v148, v140
    v_mov_b32 v149, v141
    s_nop 1
    v_permlane32_swap_b32 v134, v142
    v_permlane32_swap_b32 v135, v143
    v_permlane32_swap_b32 v136, v144
    v_permlane32_swap_b32 v137, v145
    v_permlane32_swap_b32 v138, v146
    v_permlane32_swap_b32 v139, v147
    v_permlane32_swap_b32 v140, v148
    v_permlane32_swap_b32 v141, v149
    s_nop 1
    v_add_f32 v134, v134, v142
    v_add_f32 v135, v135, v143
    v_add_f32 v136, v136, v144
    v_add_f32 v137, v137, v145
    v_add_f32 v138, v138, v146
    v_add_f32 v139, v139, v147
    v_add_f32 v140, v140, v148
    v_add_f32 v141, v141, v149
    s_lshl_b32 s68, s45, 2
    s_add_u32 s68, s68, s77
    s_lshl_b32 s68, s68, 2
    s_add_u32 s68, s68, s78
    s_lshl_b32 s68, s68, 2
    s_add_u32 s68, s68, s44
    s_lshl_b32 s68, s68, 7
    s_add_u32 s68, s68, 7340032
    v_lshlrev_b32 v4, 5, v2
    v_cmp_gt_u32 vcc, 4, v2
    s_and_saveexec_b64 s[90:91], vcc
    buffer_store_dwordx4 v[134:137], v4, s[28:31], s68 offen sc1
    buffer_store_dwordx4 v[138:141], v4, s[28:31], s68 offen offset:16 sc1
    s_mov_b64 exec, s[90:91]
    v_mov_b32 v12, 0
    v_mov_b32 v13, 0
    s_mov_b32 s69, 0
L_ep2:
    v_readfirstlane_b32 s54, v12
    s_add_u32 s69, s69, 1
    s_cmp_lg_u32 s54, 0
    s_cbranch_scc1 L_ep2ok
    s_cmp_gt_u32 s69, 0x40000
    s_cbranch_scc1 L_ep2ok
    buffer_load_dword v12, v13, s[40:43], 0 offen sc1
    s_waitcnt vmcnt(0)
    s_branch L_ep2
L_ep2ok:
L_join:
    v_and_b32 v3, 15, v2
    v_lshrrev_b32 v4, 4, v2
    s_waitcnt vmcnt(0)
    s_barrier
    s_cmp_lg_u32 s44, 0
    s_cbranch_scc1 L_nf780000
    s_lshl_b32 s68, s84, 7
    s_add_u32 s68, s68, 7864320
    v_mov_b32 v8, s54
    v_mov_b32 v9, s54
    v_mov_b32 v10, s54
    v_mov_b32 v11, s54
    v_cmp_gt_u32 vcc, 8, v2
    s_and_saveexec_b64 s[90:91], vcc
    buffer_store_dwordx4 v[8:11], v31, s[28:31], s68 offen sc1
    s_mov_b64 exec, s[90:91]
L_nf780000:
    s_add_u32 m0, s53, 0
    s_nop 0
    buffer_load_dwordx4 v64, s[96:99], s56 offen offset:0 lds
    buffer_load_dwordx4 v65, s[96:99], s56 offen offset:1024 lds
    buffer_load_dwordx4 v66, s[96:99], s56 offen offset:2048 lds
    buffer_load_dwordx4 v67, s[96:99], s56 offen offset:3072 lds
    s_add_u32 m0, s53, 4096
    s_nop 0
    buffer_load_dwordx4 v68, s[96:99], s56 offen offset:0 lds
    buffer_load_dwordx4 v69, s[96:99], s56 offen offset:1024 lds
    buffer_load_dwordx4 v70, s[96:99], s56 offen offset:2048 lds
    buffer_load_dwordx4 v71, s[96:99], s56 offen offset:3072 lds
    s_add_u32 m0, s53, 8192
    s_nop 0
    buffer_load_dwordx4 v72, s[96:99], s56 offen offset:0 lds
    buffer_load_dwordx4 v73, s[96:99], s56 offen offset:1024 lds
    s_add_u32 m0, s53, 10240
    s_nop 0
    buffer_load_dwordx4 v64, s[96:99], s57 offen offset:0 lds
    buffer_load_dwordx4 v65, s[96:99], s57 offen offset:1024 lds
    buffer_load_dwordx4 v66, s[96:99], s57 offen offset:2048 lds
    buffer_load_dwordx4 v67, s[96:99], s57 offen offset:3072 lds
    s_add_u32 m0, s53, 14336
    s_nop 0
    buffer_load_dwordx4 v68, s[96:99], s57 offen offset:0 lds
    buffer_load_dwordx4 v69, s[96:99], s57 offen offset:1024 lds
    buffer_load_dwordx4 v70, s[96:99], s57 offen offset:2048 lds
    buffer_load_dwordx4 v71, s[96:99], s57 offen offset:3072 lds
    s_add_u32 m0, s53, 18432
    s_nop 0
    buffer_load_dwordx4 v72, s[96:99], s57 offen offset:0 lds
    buffer_load_dwordx4 v73, s[96:99], s57 offen offset:1024 lds
    s_waitcnt vmcnt(10)
    ds_read_b128 v[82:85], v74 offset:0
    ds_read_b128 v[86:89], v75 offset:0
    ds_read_b128 v[90:93], v76 offset:0
    ds_read_b128 v[94:97], v77 offset:0
    ds_read_b128 v[98:101], v74 offset:1024
    ds_read_b128 v[102:105], v75 offset:1024
    ds_read_b128 v[106:109], v76 offset:1024
    ds_read_b128 v[110:113], v77 offset:1024
    ds_read_b128 v[114:117], v74 offset:2048
    s_waitcnt lgkmcnt(6)
    v_bfi_b32 v118, s55, v82, v86
    v_alignbit_b32 v122, v87, v82, 16
    v_bfi_b32 v126, s55, v83, v87
    v_alignbit_b32 v130, v88, v83, 16
    v_bfi_b32 v134, s55, v84, v88
    v_alignbit_b32 v138, v89, v84, 16
    v_bfi_b32 v142, s55, v85, v89
    v_alignbit_b32 v146, v90, v85, 16
    v_bfi_b32 v150, s55, v86, v90
    s_waitcnt lgkmcnt(4)
    v_bfi_b32 v119, s55, v91, v95
    v_alignbit_b32 v123, v96, v91, 16
    v_bfi_b32 v127, s55, v92, v96
    v_alignbit_b32 v131, v97, v92, 16
    v_bfi_b32 v135, s55, v93, v97
    v_alignbit_b32 v139, v98, v93, 16
    v_bfi_b32 v143, s55, v94, v98
    v_alignbit_b32 v147, v99, v94, 16
    v_bfi_b32 v151, s55, v95, v99
    s_waitcnt lgkmcnt(2)
    v_bfi_b32 v120, s55, v100, v104
    v_alignbit_b32 v124, v105, v100, 16
    v_bfi_b32 v128, s55, v101, v105
    v_alignbit_b32 v132, v106, v101, 16
    v_bfi_b32 v136, s55, v102, v106
    v_alignbit_b32 v140, v107, v102, 16
    v_bfi_b32 v144, s55, v103, v107
    v_alignbit_b32 v148, v108, v103, 16
    v_bfi_b32 v152, s55, v104, v108
    s_waitcnt lgkmcnt(0)
    v_bfi_b32 v121, s55, v109, v113
    v_alignbit_b32 v125, v114, v109, 16
    v_bfi_b32 v129, s55, v110, v114
    v_alignbit_b32 v133, v115, v110, 16
    v_bfi_b32 v137, s55, v111, v115
    v_alignbit_b32 v141, v116, v111, 16
    v_bfi_b32 v145, s55, v112, v116
    v_alignbit_b32 v149, v117, v112, 16
    v_bfi_b32 v153, s55, v113, v117
    s_add_u32 m0, s53, 0
    s_nop 0
    buffer_load_dwordx4 v65, s[96:99], s58 offen offset:1024 lds
    buffer_load_dwordx4 v66, s[96:99], s58 offen offset:2048 lds
    buffer_load_dwordx4 v67, s[96:99], s58 offen offset:3072 lds
    s_add_u32 m0, s53, 4096
    s_nop 0
    buffer_load_dwordx4 v68, s[96:99], s58 offen offset:0 lds
    buffer_load_dwordx4 v69, s[96:99], s58 offen offset:1024 lds
    buffer_load_dwordx4 v70, s[96:99], s58 offen offset:2048 lds
    buffer_load_dwordx4 v71, s[96:99], s58 offen offset:3072 lds
    s_add_u32 m0, s53, 8192
    s_nop 0
    buffer_load_dwordx4 v72, s[96:99], s58 offen offset:0 lds
    s_mov_b32 s69, 0
    s_mov_b32 s68, 7864320
L_p2:
    buffer_load_dword v5, v49, s[28:31], s68 offen sc1
    s_waitcnt vmcnt(0)
    v_cmp_eq_u32 vcc, s54, v5
    s_add_u32 s69, s69, 1
    s_cmp_eq_u64 vcc, exec
    s_cbranch_scc1 L_p2ok
    s_cmp_lt_u32 s69, 0x40000
    s_cbranch_scc1 L_p2
L_p2ok:
    s_add_u32 m0, s53, 20480
    s_add_u32 s77, s64, 65536
    buffer_load_dwordx4 v16, s[28:31], s77 offen offset:0 lds
    buffer_load_dwordx4 v17, s[28:31], s77 offen offset:1024 lds
    buffer_load_dwordx4 v18, s[28:31], s77 offen offset:2048 lds
    buffer_load_dwordx4 v19, s[28:31], s77 offen offset:3072 lds
    s_add_u32 m0, s53, 24576
    s_nop 0
    buffer_load_dwordx4 v20, s[28:31], s77 offen offset:0 lds
    buffer_load_dwordx4 v21, s[28:31], s77 offen offset:1024 lds
    buffer_load_dwordx4 v22, s[28:31], s77 offen offset:2048 lds
    buffer_load_dwordx4 v23, s[28:31], s77 offen offset:3072 lds
    s_add_u32 m0, s53, 28672
    s_nop 0
    buffer_load_dwordx4 v24, s[28:31], s77 offen offset:0 lds
    buffer_load_dwordx4 v25, s[28:31], s77 offen offset:1024 lds
    buffer_load_dwordx4 v26, s[28:31], s77 offen offset:2048 lds
    buffer_load_dwordx4 v27, s[28:31], s77 offen offset:3072 lds
    ds_read_b128 v[82:85], v74 offset:10240
    ds_read_b128 v[86:89], v75 offset:10240
    ds_read_b128 v[90:93], v76 offset:10240
    ds_read_b128 v[94:97], v77 offset:10240
    ds_read_b128 v[98:101], v74 offset:11264
    ds_read_b128 v[102:105], v75 offset:11264
    ds_read_b128 v[106:109], v76 offset:11264
    ds_read_b128 v[110:113], v77 offset:11264
    ds_read_b128 v[114:117], v74 offset:12288
    s_waitcnt lgkmcnt(6)
    v_bfi_b32 v154, s55, v82, v86
    v_alignbit_b32 v158, v87, v82, 16
    v_bfi_b32 v162, s55, v83, v87
    v_alignbit_b32 v166, v88, v83, 16
    v_bfi_b32 v170, s55, v84, v88
    v_alignbit_b32 v174, v89, v84, 16
    v_bfi_b32 v178, s55, v85, v89
    v_alignbit_b32 v182, v90, v85, 16
    v_bfi_b32 v186, s55, v86, v90
    s_waitcnt lgkmcnt(4)
    v_bfi_b32 v155, s55, v91, v95
    v_alignbit_b32 v159, v96, v91, 16
    v_bfi_b32 v163, s55, v92, v96
    v_alignbit_b32 v167, v97, v92, 16
    v_bfi_b32 v171, s55, v93, v97
    v_alignbit_b32 v175, v98, v93, 16
    v_bfi_b32 v179, s55, v94, v98
    v_alignbit_b32 v183, v99, v94, 16
    v_bfi_b32 v187, s55, v95, v99
    s_waitcnt lgkmcnt(2)
    v_bfi_b32 v156, s55, v100, v104
    v_alignbit_b32 v160, v105, v100, 16
    v_bfi_b32 v164, s55, v101, v105
    v_alignbit_b32 v168, v106, v101, 16
    v_bfi_b32 v172, s55, v102, v106
    v_alignbit_b32 v176, v107, v102, 16
    v_bfi_b32 v180, s55, v103, v107
    v_alignbit_b32 v184, v108, v103, 16
    v_bfi_b32 v188, s55, v104, v108
    s_waitcnt lgkmcnt(0)
    v_bfi_b32 v157, s55, v109, v113
    v_alignbit_b32 v161, v114, v109, 16
    v_bfi_b32 v165, s55, v110, v114
    v_alignbit_b32 v169, v115, v110, 16
    v_bfi_b32 v173, s55, v111, v115
    v_alignbit_b32 v177, v116, v111, 16
    v_bfi_b32 v181, s55, v112, v116
    v_alignbit_b32 v185, v117, v112, 16
    v_bfi_b32 v189, s55, v113, v117
    s_waitcnt vmcnt(8)
    ds_read_b128 a[64:67], v29 offset:0
    ds_read_b128 a[68:71], v28 offset:0
    ds_read_b128 a[72:75], v28 offset:16
    ds_read_b128 a[76:79], v28 offset:240
    ds_read_b128 a[80:83], v28 offset:256
    ds_read_b128 a[84:87], v30 offset:272
    ds_read_b128 a[88:91], v29 offset:512
    ds_read_b128 a[92:95], v28 offset:512
    ds_read_b128 a[96:99], v28 offset:528
    ds_read_b128 a[100:103], v28 offset:752
    ds_read_b128 a[104:107], v28 offset:768
    ds_read_b128 a[108:111], v30 offset:784
    s_waitcnt vmcnt(4)
    ds_read_b128 a[112:115], v29 offset:4096
    ds_read_b128 a[116:119], v28 offset:4096
    ds_read_b128 a[120:123], v28 offset:4112
    ds_read_b128 a[124:127], v28 offset:4336
    ds_read_b128 a[128:131], v28 offset:4352
    ds_read_b128 a[132:135], v30 offset:4368
    s_waitcnt lgkmcnt(15)
    v_mfma_f32_16x16x32_bf16 a[0:3], v[118:121], a[64:67], 0
    v_mfma_f32_16x16x32_bf16 a[0:3], v[122:125], a[68:71], a[0:3]
    ds_read_b128 a[136:139], v29 offset:4608
    v_mfma_f32_16x16x32_bf16 a[0:3], v[126:129], a[72:75], a[0:3]
    ds_read_b128 a[140:143], v28 offset:4608
    s_waitcnt lgkmcnt(11)
    v_mfma_f32_16x16x32_bf16 a[0:3], v[130:133], a[88:91], a[0:3]
    s_add_u32 m0, s53, 32768
    s_add_u32 s77, s65, 65536
    v_mfma_f32_16x16x32_bf16 a[0:3], v[134:137], a[92:95], a[0:3]
    ds_read_b128 a[144:147], v28 offset:4624
    v_mfma_f32_16x16x32_bf16 a[0:3], v[138:141], a[96:99], a[0:3]
    s_waitcnt lgkmcnt(6)
    v_mfma_f32_16x16x32_bf16 a[0:3], v[142:145], a[112:115], a[0:3]
    buffer_load_dwordx4 v16, s[28:31], s77 offen offset:0 lds
    v_mfma_f32_16x16x32_bf16 a[0:3], v[146:149], a[116:119], a[0:3]
    ds_read_b128 a[148:151], v28 offset:4848
    ds_read_b128 a[152:155], v28 offset:4864
    v_mfma_f32_16x16x32_bf16 a[0:3], v[150:153], a[120:123], a[0:3]
    ds_read_b128 a[156:159], v30 offset:4880
    v_mfma_f32_16x16x32_bf16 a[4:7], v[118:121], a[76:79], 0
    buffer_load_dwordx4 v17, s[28:31], s77 offen offset:1024 lds
    v_mfma_f32_16x16x32_bf16 a[4:7], v[122:125], a[80:83], a[4:7]
    v_mfma_f32_16x16x32_bf16 a[4:7], v[126:129], a[84:87], a[4:7]
    v_mfma_f32_16x16x32_bf16 a[4:7], v[130:133], a[100:103], a[4:7]
    v_mfma_f32_16x16x32_bf16 a[4:7], v[134:137], a[104:107], a[4:7]
    v_mfma_f32_16x16x32_bf16 a[4:7], v[138:141], a[108:111], a[4:7]
    s_waitcnt lgkmcnt(6)
    v_mfma_f32_16x16x32_bf16 a[4:7], v[142:145], a[124:127], a[4:7]
    buffer_load_dwordx4 v18, s[28:31], s77 offen offset:2048 lds
    v_mfma_f32_16x16x32_bf16 a[4:7], v[146:149], a[128:131], a[4:7]
    v_mfma_f32_16x16x32_bf16 a[4:7], v[150:153], a[132:135], a[4:7]
    v_mfma_f32_16x16x32_bf16 a[8:11], v[118:121], a[88:91], 0
    v_mfma_f32_16x16x32_bf16 a[8:11], v[122:125], a[92:95], a[8:11]
    buffer_load_dwordx4 v19, s[28:31], s77 offen offset:3072 lds
    v_mfma_f32_16x16x32_bf16 a[8:11], v[126:129], a[96:99], a[8:11]
    v_mfma_f32_16x16x32_bf16 a[8:11], v[130:133], a[112:115], a[8:11]
    v_mfma_f32_16x16x32_bf16 a[8:11], v[134:137], a[116:119], a[8:11]
    v_mfma_f32_16x16x32_bf16 a[8:11], v[138:141], a[120:123], a[8:11]
    s_waitcnt lgkmcnt(3)
    v_mfma_f32_16x16x32_bf16 a[8:11], v[142:145], a[136:139], a[8:11]
    s_waitcnt vmcnt(4)
    ds_read_b128 a[160:163], v29 offset:8192
    v_mfma_f32_16x16x32_bf16 a[8:11], v[146:149], a[140:143], a[8:11]
    s_add_u32 m0, s53, 10240
    ds_read_b128 a[164:167], v28 offset:8192
    v_mfma_f32_16x16x32_bf16 a[8:11], v[150:153], a[144:147], a[8:11]
    buffer_load_dwordx4 v65, s[96:99], s59 offen offset:1024 lds
    v_mfma_f32_16x16x32_bf16 a[12:15], v[118:121], a[100:103], 0
    ds_read_b128 a[168:171], v28 offset:8208
    ds_read_b128 a[172:175], v28 offset:8432
    v_mfma_f32_16x16x32_bf16 a[12:15], v[122:125], a[104:107], a[12:15]
    v_mfma_f32_16x16x32_bf16 a[12:15], v[126:129], a[108:111], a[12:15]
    ds_read_b128 a[176:179], v28 offset:8448
    v_mfma_f32_16x16x32_bf16 a[12:15], v[130:133], a[124:127], a[12:15]
    buffer_load_dwordx4 v66, s[96:99], s59 offen offset:2048 lds
    v_mfma_f32_16x16x32_bf16 a[12:15], v[134:137], a[128:131], a[12:15]
    ds_read_b128 a[180:183], v30 offset:8464
    ds_read_b128 v[82:85], v78 offset:0
    v_mfma_f32_16x16x32_bf16 a[12:15], v[138:141], a[132:135], a[12:15]
    ds_read_b128 v[86:89], v79 offset:0
    s_waitcnt lgkmcnt(8)
    v_mfma_f32_16x16x32_bf16 a[12:15], v[142:145], a[148:151], a[12:15]
    v_mfma_f32_16x16x32_bf16 a[12:15], v[146:149], a[152:155], a[12:15]
    ds_read_b128 v[90:93], v80 offset:0
    v_mfma_f32_16x16x32_bf16 a[12:15], v[150:153], a[156:159], a[12:15]
    buffer_load_dwordx4 v67, s[96:99], s59 offen offset:3072 lds
    v_mfma_f32_16x16x32_bf16 a[16:19], v[118:121], a[112:115], 0
    ds_read_b128 v[94:97], v81 offset:0
    v_mfma_f32_16x16x32_bf16 a[16:19], v[122:125], a[116:119], a[16:19]
    v_mfma_f32_16x16x32_bf16 a[16:19], v[126:129], a[120:123], a[16:19]
    ds_read_b128 v[98:101], v74 offset:1024
    s_add_u32 m0, s53, 14336
    v_mfma_f32_16x16x32_bf16 a[16:19], v[130:133], a[136:139], a[16:19]
    buffer_load_dwordx4 v68, s[96:99], s59 offen offset:0 lds
    v_mfma_f32_16x16x32_bf16 a[16:19], v[134:137], a[140:143], a[16:19]
    ds_read_b128 v[102:105], v75 offset:1024
    v_mfma_f32_16x16x32_bf16 a[16:19], v[138:141], a[144:147], a[16:19]
    ds_read_b128 a[184:187], v29 offset:8704
    s_waitcnt lgkmcnt(10)
    v_mfma_f32_16x16x32_bf16 a[16:19], v[142:145], a[160:163], a[16:19]
    ds_read_b128 a[188:191], v28 offset:8704
    ds_read_b128 v[106:109], v76 offset:1024
    v_mfma_f32_16x16x32_bf16 a[16:19], v[146:149], a[164:167], a[16:19]
    v_mfma_f32_16x16x32_bf16 a[16:19], v[150:153], a[168:171], a[16:19]
    ds_read_b128 a[192:195], v28 offset:8720
    ds_read_b128 v[110:113], v77 offset:1024
    v_mfma_f32_16x16x32_bf16 a[20:23], v[118:121], a[124:127], 0
    buffer_load_dwordx4 v69, s[96:99], s59 offen offset:1024 lds
    v_mfma_f32_16x16x32_bf16 a[20:23], v[122:125], a[128:131], a[20:23]
    ds_read_b128 a[196:199], v28 offset:8944
    ds_read_b128 v[114:117], v74 offset:2048
    v_mfma_f32_16x16x32_bf16 a[20:23], v[126:129], a[132:135], a[20:23]
    ds_read_b128 a[200:203], v28 offset:8960
    v_mfma_f32_16x16x32_bf16 a[20:23], v[130:133], a[148:151], a[20:23]
    ds_read_b128 a[204:207], v30 offset:8976
    v_mfma_f32_16x16x32_bf16 a[20:23], v[134:137], a[152:155], a[20:23]
    buffer_load_dwordx4 v70, s[96:99], s59 offen offset:2048 lds
    v_mfma_f32_16x16x32_bf16 a[20:23], v[138:141], a[156:159], a[20:23]
    s_waitcnt lgkmcnt(15)
    v_mfma_f32_16x16x32_bf16 a[20:23], v[142:145], a[172:175], a[20:23]
    v_mfma_f32_16x16x32_bf16 a[20:23], v[146:149], a[176:179], a[20:23]
    v_mfma_f32_16x16x32_bf16 a[20:23], v[150:153], a[180:183], a[20:23]
    v_mfma_f32_16x16x32_bf16 a[24:27], v[118:121], a[136:139], 0
    buffer_load_dwordx4 v71, s[96:99], s59 offen offset:3072 lds
    v_mfma_f32_16x16x32_bf16 a[24:27], v[122:125], a[140:143], a[24:27]
    v_mfma_f32_16x16x32_bf16 a[24:27], v[126:129], a[144:147], a[24:27]
    v_mfma_f32_16x16x32_bf16 a[24:27], v[130:133], a[160:163], a[24:27]
    v_mfma_f32_16x16x32_bf16 a[24:27], v[134:137], a[164:167], a[24:27]
    s_add_u32 m0, s53, 18432
    v_mfma_f32_16x16x32_bf16 a[24:27], v[138:141], a[168:171], a[24:27]
    s_waitcnt lgkmcnt(5)
    v_mfma_f32_16x16x32_bf16 a[24:27], v[142:145], a[184:187], a[24:27]
    buffer_load_dwordx4 v72, s[96:99], s59 offen offset:0 lds
    v_mfma_f32_16x16x32_bf16 a[24:27], v[146:149], a[188:191], a[24:27]
    v_mfma_f32_16x16x32_bf16 a[24:27], v[150:153], a[192:195], a[24:27]
    v_mfma_f32_16x16x32_bf16 a[28:31], v[118:121], a[148:151], 0
    s_add_u32 m0, s53, 36864
    v_mfma_f32_16x16x32_bf16 a[28:31], v[122:125], a[152:155], a[28:31]
    buffer_load_dwordx4 v20, s[28:31], s77 offen offset:0 lds
    v_mfma_f32_16x16x32_bf16 a[28:31], v[126:129], a[156:159], a[28:31]
    v_mfma_f32_16x16x32_bf16 a[28:31], v[130:133], a[172:175], a[28:31]
    v_mfma_f32_16x16x32_bf16 a[28:31], v[134:137], a[176:179], a[28:31]
    v_mfma_f32_16x16x32_bf16 a[28:31], v[138:141], a[180:183], a[28:31]
    s_waitcnt lgkmcnt(0)
    v_mfma_f32_16x16x32_bf16 a[28:31], v[142:145], a[196:199], a[28:31]
    buffer_load_dwordx4 v21, s[28:31], s77 offen offset:1024 lds
    v_mfma_f32_16x16x32_bf16 a[28:31], v[146:149], a[200:203], a[28:31]
    v_mfma_f32_16x16x32_bf16 a[28:31], v[150:153], a[204:207], a[28:31]
    v_mfma_f32_16x16x32_bf16 a[32:35], v[154:157], a[64:67], 0
    v_mfma_f32_16x16x32_bf16 a[32:35], v[158:161], a[68:71], a[32:35]
    v_bfi_b32 v118, s55, v82, v86
    v_mfma_f32_16x16x32_bf16 a[32:35], v[162:165], a[72:75], a[32:35]
    v_alignbit_b32 v122, v87, v82, 16
    v_mfma_f32_16x16x32_bf16 a[32:35], v[166:169], a[88:91], a[32:35]
    buffer_load_dwordx4 v22, s[28:31], s77 offen offset:2048 lds
    v_mfma_f32_16x16x32_bf16 a[32:35], v[170:173], a[92:95], a[32:35]
    s_mov_b32 s69, 7864320
    v_bfi_b32 v126, s55, v83, v87
    v_mfma_f32_16x16x32_bf16 a[32:35], v[174:177], a[96:99], a[32:35]
    buffer_load_dword v48, v54, s[28:31], s69 offen sc1
    v_mfma_f32_16x16x32_bf16 a[32:35], v[178:181], a[112:115], a[32:35]
    v_alignbit_b32 v130, v88, v83, 16
    v_bfi_b32 v134, s55, v84, v88
    v_mfma_f32_16x16x32_bf16 a[32:35], v[182:185], a[116:119], a[32:35]
    v_alignbit_b32 v138, v89, v84, 16
    v_mfma_f32_16x16x32_bf16 a[32:35], v[186:189], a[120:123], a[32:35]
    buffer_load_dwordx4 v23, s[28:31], s77 offen offset:3072 lds
    v_mfma_f32_16x16x32_bf16 a[36:39], v[154:157], a[76:79], 0
    v_bfi_b32 v142, s55, v85, v89
    v_mfma_f32_16x16x32_bf16 a[36:39], v[158:161], a[80:83], a[36:39]
    v_alignbit_b32 v146, v90, v85, 16
    v_mfma_f32_16x16x32_bf16 a[36:39], v[162:165], a[84:87], a[36:39]
    v_bfi_b32 v150, s55, v86, v90
    s_add_u32 m0, s53, 20480
    v_mfma_f32_16x16x32_bf16 a[36:39], v[166:169], a[100:103], a[36:39]
    buffer_load_dwordx4 v24, s[28:31], s77 offen offset:0 lds
    v_mfma_f32_16x16x32_bf16 a[36:39], v[170:173], a[104:107], a[36:39]
    v_bfi_b32 v119, s55, v91, v95
    v_mfma_f32_16x16x32_bf16 a[36:39], v[174:177], a[108:111], a[36:39]
    v_alignbit_b32 v123, v96, v91, 16
    v_mfma_f32_16x16x32_bf16 a[36:39], v[178:181], a[124:127], a[36:39]
    v_bfi_b32 v127, s55, v92, v96
    v_mfma_f32_16x16x32_bf16 a[36:39], v[182:185], a[128:131], a[36:39]
    v_mfma_f32_16x16x32_bf16 a[36:39], v[186:189], a[132:135], a[36:39]
    v_alignbit_b32 v131, v97, v92, 16
    v_mfma_f32_16x16x32_bf16 a[40:43], v[154:157], a[88:91], 0
    buffer_load_dwordx4 v25, s[28:31], s77 offen offset:1024 lds
    v_mfma_f32_16x16x32_bf16 a[40:43], v[158:161], a[92:95], a[40:43]
    v_bfi_b32 v135, s55, v93, v97
    v_mfma_f32_16x16x32_bf16 a[40:43], v[162:165], a[96:99], a[40:43]
    s_waitcnt vmcnt(15)
    ds_read_b128 a[64:67], v29 offset:12288
    v_mfma_f32_16x16x32_bf16 a[40:43], v[166:169], a[112:115], a[40:43]
    v_alignbit_b32 v139, v98, v93, 16
    ds_read_b128 a[68:71], v28 offset:12288
    v_mfma_f32_16x16x32_bf16 a[40:43], v[170:173], a[116:119], a[40:43]
    v_bfi_b32 v143, s55, v94, v98
    ds_read_b128 a[72:75], v28 offset:12304
    v_mfma_f32_16x16x32_bf16 a[40:43], v[174:177], a[120:123], a[40:43]
    v_alignbit_b32 v147, v99, v94, 16
    v_mfma_f32_16x16x32_bf16 a[40:43], v[178:181], a[136:139], a[40:43]
    buffer_load_dwordx4 v26, s[28:31], s77 offen offset:2048 lds
    v_mfma_f32_16x16x32_bf16 a[40:43], v[182:185], a[140:143], a[40:43]
    ds_read_b128 a[76:79], v28 offset:12528
    v_bfi_b32 v151, s55, v95, v99
    v_mfma_f32_16x16x32_bf16 a[40:43], v[186:189], a[144:147], a[40:43]
    ds_read_b128 a[80:83], v28 offset:12544
    v_bfi_b32 v120, s55, v100, v104
    v_mfma_f32_16x16x32_bf16 a[44:47], v[154:157], a[100:103], 0
    ds_read_b128 a[84:87], v30 offset:12560
    v_alignbit_b32 v124, v105, v100, 16
    v_mfma_f32_16x16x32_bf16 a[44:47], v[158:161], a[104:107], a[44:47]
    v_bfi_b32 v128, s55, v101, v105
    v_mfma_f32_16x16x32_bf16 a[44:47], v[162:165], a[108:111], a[44:47]
    buffer_load_dwordx4 v27, s[28:31], s77 offen offset:3072 lds
    v_mfma_f32_16x16x32_bf16 a[44:47], v[166:169], a[124:127], a[44:47]
    v_alignbit_b32 v132, v106, v101, 16
    v_bfi_b32 v136, s55, v102, v106
    v_mfma_f32_16x16x32_bf16 a[44:47], v[170:173], a[128:131], a[44:47]
    v_alignbit_b32 v140, v107, v102, 16
    s_add_u32 m0, s53, 0
    v_mfma_f32_16x16x32_bf16 a[44:47], v[174:177], a[132:135], a[44:47]
    buffer_load_dwordx4 v64, s[96:99], s60 offen offset:0 lds
    v_mfma_f32_16x16x32_bf16 a[44:47], v[178:181], a[148:151], a[44:47]
    v_bfi_b32 v144, s55, v103, v107
    v_mfma_f32_16x16x32_bf16 a[44:47], v[182:185], a[152:155], a[44:47]
    v_alignbit_b32 v148, v108, v103, 16
    v_mfma_f32_16x16x32_bf16 a[44:47], v[186:189], a[156:159], a[44:47]
    v_bfi_b32 v152, s55, v104, v108
    v_mfma_f32_16x16x32_bf16 a[48:51], v[154:157], a[112:115], 0
    v_mfma_f32_16x16x32_bf16 a[48:51], v[158:161], a[116:119], a[48:51]
    ds_read_b128 a[88:91], v29 offset:12800
    v_bfi_b32 v121, s55, v109, v113
    v_mfma_f32_16x16x32_bf16 a[48:51], v[162:165], a[120:123], a[48:51]
    buffer_load_dwordx4 v65, s[96:99], s60 offen offset:1024 lds
    v_mfma_f32_16x16x32_bf16 a[48:51], v[166:169], a[136:139], a[48:51]
    ds_read_b128 a[92:95], v28 offset:12800
    v_alignbit_b32 v125, v114, v109, 16
    v_mfma_f32_16x16x32_bf16 a[48:51], v[170:173], a[140:143], a[48:51]
    v_bfi_b32 v129, s55, v110, v114
    ds_read_b128 a[96:99], v28 offset:12816
    v_mfma_f32_16x16x32_bf16 a[48:51], v[174:177], a[144:147], a[48:51]
    ds_read_b128 a[100:103], v28 offset:13040
    v_alignbit_b32 v133, v115, v110, 16
    v_mfma_f32_16x16x32_bf16 a[48:51], v[178:181], a[160:163], a[48:51]
    v_bfi_b32 v137, s55, v111, v115
    v_mfma_f32_16x16x32_bf16 a[48:51], v[182:185], a[164:167], a[48:51]
    buffer_load_dwordx4 v66, s[96:99], s60 offen offset:2048 lds
    v_mfma_f32_16x16x32_bf16 a[48:51], v[186:189], a[168:171], a[48:51]
    ds_read_b128 a[104:107], v28 offset:13056
    v_alignbit_b32 v141, v116, v111, 16
    v_mfma_f32_16x16x32_bf16 a[52:55], v[154:157], a[124:127], 0
    ds_read_b128 a[108:111], v30 offset:13072
    v_bfi_b32 v145, s55, v112, v116
    v_mfma_f32_16x16x32_bf16 a[52:55], v[158:161], a[128:131], a[52:55]
    v_alignbit_b32 v149, v117, v112, 16
    v_mfma_f32_16x16x32_bf16 a[52:55], v[162:165], a[132:135], a[52:55]
    v_bfi_b32 v153, s55, v113, v117
    v_mfma_f32_16x16x32_bf16 a[52:55], v[166:169], a[148:151], a[52:55]
    buffer_load_dwordx4 v67, s[96:99], s60 offen offset:3072 lds
    v_mfma_f32_16x16x32_bf16 a[52:55], v[170:173], a[152:155], a[52:55]
    v_mfma_f32_16x16x32_bf16 a[52:55], v[174:177], a[156:159], a[52:55]
    v_mfma_f32_16x16x32_bf16 a[52:55], v[178:181], a[172:175], a[52:55]
    s_add_u32 m0, s53, 4096
    v_mfma_f32_16x16x32_bf16 a[52:55], v[182:185], a[176:179], a[52:55]
    s_waitcnt vmcnt(13)
    ds_read_b128 v[82:85], v78 offset:10240
    v_mfma_f32_16x16x32_bf16 a[52:55], v[186:189], a[180:183], a[52:55]
    buffer_load_dwordx4 v68, s[96:99], s60 offen offset:0 lds
    v_mfma_f32_16x16x32_bf16 a[56:59], v[154:157], a[136:139], 0
    ds_read_b128 v[86:89], v79 offset:10240
    v_mfma_f32_16x16x32_bf16 a[56:59], v[158:161], a[140:143], a[56:59]
    s_waitcnt vmcnt(9)
    ds_read_b128 a[112:115], v29 offset:16384
    v_mfma_f32_16x16x32_bf16 a[56:59], v[162:165], a[144:147], a[56:59]
    ds_read_b128 a[116:119], v28 offset:16384
    ds_read_b128 v[90:93], v80 offset:10240
    v_mfma_f32_16x16x32_bf16 a[56:59], v[166:169], a[160:163], a[56:59]
    buffer_load_dwordx4 v69, s[96:99], s60 offen offset:1024 lds
    v_mfma_f32_16x16x32_bf16 a[56:59], v[170:173], a[164:167], a[56:59]
    ds_read_b128 a[120:123], v28 offset:16400
    ds_read_b128 v[94:97], v81 offset:10240
    v_mfma_f32_16x16x32_bf16 a[56:59], v[174:177], a[168:171], a[56:59]
    ds_read_b128 a[124:127], v28 offset:16624
    v_mfma_f32_16x16x32_bf16 a[56:59], v[178:181], a[184:187], a[56:59]
    ds_read_b128 v[98:101], v74 offset:11264
    v_mfma_f32_16x16x32_bf16 a[56:59], v[182:185], a[188:191], a[56:59]
    ds_read_b128 a[128:131], v28 offset:16640
    v_mfma_f32_16x16x32_bf16 a[56:59], v[186:189], a[192:195], a[56:59]
    ds_read_b128 a[132:135], v30 offset:16656
    ds_read_b128 v[102:105], v75 offset:11264
    v_mfma_f32_16x16x32_bf16 a[60:63], v[154:157], a[148:151], 0
    buffer_load_dwordx4 v70, s[96:99], s60 offen offset:2048 lds
    v_mfma_f32_16x16x32_bf16 a[60:63], v[158:161], a[152:155], a[60:63]
    ds_read_b128 v[106:109], v76 offset:11264
    v_mfma_f32_16x16x32_bf16 a[60:63], v[162:165], a[156:159], a[60:63]
    v_mfma_f32_16x16x32_bf16 a[60:63], v[166:169], a[172:175], a[60:63]
    ds_read_b128 v[110:113], v77 offset:11264
    v_mfma_f32_16x16x32_bf16 a[60:63], v[170:173], a[176:179], a[60:63]
    buffer_load_dwordx4 v71, s[96:99], s60 offen offset:3072 lds
    v_mfma_f32_16x16x32_bf16 a[60:63], v[174:177], a[180:183], a[60:63]
    ds_read_b128 v[114:117], v74 offset:12288
    v_mfma_f32_16x16x32_bf16 a[60:63], v[178:181], a[196:199], a[60:63]
    v_mfma_f32_16x16x32_bf16 a[60:63], v[182:185], a[200:203], a[60:63]
    v_mfma_f32_16x16x32_bf16 a[60:63], v[186:189], a[204:207], a[60:63]
    s_add_u32 m0, s53, 8192
    s_waitcnt lgkmcnt(15)
    v_mfma_f32_16x16x32_bf16 a[0:3], v[118:121], a[64:67], a[0:3]
    buffer_load_dwordx4 v72, s[96:99], s60 offen offset:0 lds
    v_mfma_f32_16x16x32_bf16 a[0:3], v[122:125], a[68:71], a[0:3]
    ds_read_b128 a[136:139], v29 offset:16896
    v_mfma_f32_16x16x32_bf16 a[0:3], v[126:129], a[72:75], a[0:3]
    s_waitcnt lgkmcnt(11)
    v_bfi_b32 v154, s55, v82, v86
    v_mfma_f32_16x16x32_bf16 a[0:3], v[130:133], a[88:91], a[0:3]
    ds_read_b128 a[140:143], v28 offset:16896
    v_alignbit_b32 v158, v87, v82, 16
    v_mfma_f32_16x16x32_bf16 a[0:3], v[134:137], a[92:95], a[0:3]
    v_bfi_b32 v162, s55, v83, v87
    ds_read_b128 a[144:147], v28 offset:16912
    v_mfma_f32_16x16x32_bf16 a[0:3], v[138:141], a[96:99], a[0:3]
    ds_read_b128 a[148:151], v28 offset:17136
    s_waitcnt lgkmcnt(13)
    v_mfma_f32_16x16x32_bf16 a[0:3], v[142:145], a[112:115], a[0:3]
    v_alignbit_b32 v166, v88, v83, 16
    v_mfma_f32_16x16x32_bf16 a[0:3], v[146:149], a[116:119], a[0:3]
    buffer_load_dwordx4 v73, s[96:99], s60 offen offset:1024 lds
    v_mfma_f32_16x16x32_bf16 a[0:3], v[150:153], a[120:123], a[0:3]
    v_bfi_b32 v170, s55, v84, v88
    ds_read_b128 a[152:155], v28 offset:17152
    v_mfma_f32_16x16x32_bf16 a[4:7], v[118:121], a[76:79], a[4:7]
    v_alignbit_b32 v174, v89, v84, 16
    ds_read_b128 a[156:159], v30 offset:17168
    v_mfma_f32_16x16x32_bf16 a[4:7], v[122:125], a[80:83], a[4:7]
    v_bfi_b32 v178, s55, v85, v89
    v_mfma_f32_16x16x32_bf16 a[4:7], v[126:129], a[84:87], a[4:7]
    s_add_u32 m0, s53, 24576
    s_add_u32 s77, s66, 65536
    v_mfma_f32_16x16x32_bf16 a[4:7], v[130:133], a[100:103], a[4:7]
    v_alignbit_b32 v182, v90, v85, 16
    v_mfma_f32_16x16x32_bf16 a[4:7], v[134:137], a[104:107], a[4:7]
    buffer_load_dwordx4 v16, s[28:31], s77 offen offset:0 lds
    v_mfma_f32_16x16x32_bf16 a[4:7], v[138:141], a[108:111], a[4:7]
    v_bfi_b32 v186, s55, v86, v90
    s_waitcnt lgkmcnt(10)
    v_mfma_f32_16x16x32_bf16 a[4:7], v[142:145], a[124:127], a[4:7]
    v_bfi_b32 v155, s55, v91, v95
    v_alignbit_b32 v159, v96, v91, 16
    v_mfma_f32_16x16x32_bf16 a[4:7], v[146:149], a[128:131], a[4:7]
    v_bfi_b32 v163, s55, v92, v96
    v_mfma_f32_16x16x32_bf16 a[4:7], v[150:153], a[132:135], a[4:7]
    buffer_load_dwordx4 v17, s[28:31], s77 offen offset:1024 lds
    v_mfma_f32_16x16x32_bf16 a[8:11], v[118:121], a[88:91], a[8:11]
    v_alignbit_b32 v167, v97, v92, 16
    v_bfi_b32 v171, s55, v93, v97
    v_mfma_f32_16x16x32_bf16 a[8:11], v[122:125], a[92:95], a[8:11]
    v_alignbit_b32 v175, v98, v93, 16
    v_mfma_f32_16x16x32_bf16 a[8:11], v[126:129], a[96:99], a[8:11]
    buffer_load_dwordx4 v18, s[28:31], s77 offen offset:2048 lds
    v_mfma_f32_16x16x32_bf16 a[8:11], v[130:133], a[112:115], a[8:11]
    v_cmp_eq_u32 vcc, s54, v48
    s_nop 0
    s_cmp_eq_u64 vcc, exec
    s_cbranch_scc0 L_embslow
L_embok:
    v_mfma_f32_16x16x32_bf16 a[8:11], v[134:137], a[116:119], a[8:11]
    v_bfi_b32 v179, s55, v94, v98
    v_alignbit_b32 v183, v99, v94, 16
    v_mfma_f32_16x16x32_bf16 a[8:11], v[138:141], a[120:123], a[8:11]
    s_waitcnt lgkmcnt(3)
    v_mfma_f32_16x16x32_bf16 a[8:11], v[142:145], a[136:139], a[8:11]
    s_waitcnt vmcnt(13)
    ds_read_b128 a[160:163], v29 offset:0
    v_mfma_f32_16x16x32_bf16 a[8:11], v[146:149], a[140:143], a[8:11]
    v_bfi_b32 v187, s55, v95, v99
    ds_read_b128 a[164:167], v28 offset:0
    v_mfma_f32_16x16x32_bf16 a[8:11], v[150:153], a[144:147], a[8:11]
    s_lshl_b32 s68, s45, 2
    s_add_u32 s68, s68, s49
    v_mfma_f32_16x16x32_bf16 a[12:15], v[118:121], a[100:103], a[12:15]
    v_bfi_b32 v156, s55, v100, v104
    v_mfma_f32_16x16x32_bf16 a[12:15], v[122:125], a[104:107], a[12:15]
    buffer_load_dwordx4 v19, s[28:31], s77 offen offset:3072 lds
    v_mfma_f32_16x16x32_bf16 a[12:15], v[126:129], a[108:111], a[12:15]
    ds_read_b128 a[168:171], v28 offset:16
    v_alignbit_b32 v160, v105, v100, 16
    v_mfma_f32_16x16x32_bf16 a[12:15], v[130:133], a[124:127], a[12:15]
    ds_read_b128 a[172:175], v28 offset:240
    v_bfi_b32 v164, s55, v101, v105
    v_mfma_f32_16x16x32_bf16 a[12:15], v[134:137], a[128:131], a[12:15]
    s_lshl_b32 s68, s68, 11
    s_add_u32 s68, s68, 7340032
    v_mfma_f32_16x16x32_bf16 a[12:15], v[138:141], a[132:135], a[12:15]
    ds_read_b128 a[176:179], v28 offset:256
    s_waitcnt lgkmcnt(5)
    v_mfma_f32_16x16x32_bf16 a[12:15], v[142:145], a[148:151], a[12:15]
    v_alignbit_b32 v168, v106, v101, 16
    s_add_u32 m0, s53, 10240
    v_mfma_f32_16x16x32_bf16 a[12:15], v[146:149], a[152:155], a[12:15]
    ds_read_b128 a[180:183], v30 offset:272
    v_bfi_b32 v172, s55, v102, v106
    v_mfma_f32_16x16x32_bf16 a[12:15], v[150:153], a[156:159], a[12:15]
    buffer_load_dwordx4 v64, s[96:99], s61 offen offset:0 lds
    v_mfma_f32_16x16x32_bf16 a[16:19], v[118:121], a[112:115], a[16:19]
    v_lshlrev_b32 v5, 7, v3
    v_lshl_add_u32 v5, v4, 4, v5
    v_mfma_f32_16x16x32_bf16 a[16:19], v[122:125], a[116:119], a[16:19]
    v_alignbit_b32 v176, v107, v102, 16
    v_bfi_b32 v180, s55, v103, v107
    v_mfma_f32_16x16x32_bf16 a[16:19], v[126:129], a[120:123], a[16:19]
    buffer_load_dwordx4 v[32:35], v5, s[28:31], s68 offen offset:0 sc1
    v_mfma_f32_16x16x32_bf16 a[16:19], v[130:133], a[136:139], a[16:19]
    v_alignbit_b32 v184, v108, v103, 16
    v_bfi_b32 v188, s55, v104, v108
    v_mfma_f32_16x16x32_bf16 a[16:19], v[134:137], a[140:143], a[16:19]
    buffer_load_dwordx4 v65, s[96:99], s61 offen offset:1024 lds
    v_mfma_f32_16x16x32_bf16 a[16:19], v[138:141], a[144:147], a[16:19]
    s_waitcnt lgkmcnt(3)
    v_mfma_f32_16x16x32_bf16 a[16:19], v[142:145], a[160:163], a[16:19]
    buffer_load_dwordx4 v[36:39], v5, s[28:31], s68 offen offset:64 sc1
    v_mfma_f32_16x16x32_bf16 a[16:19], v[146:149], a[164:167], a[16:19]
    v_bfi_b32 v157, s55, v109, v113
    v_alignbit_b32 v161, v114, v109, 16
    v_mfma_f32_16x16x32_bf16 a[16:19], v[150:153], a[168:171], a[16:19]
    v_bfi_b32 v165, s55, v110, v114
    v_mfma_f32_16x16x32_bf16 a[20:23], v[118:121], a[124:127], a[20:23]
    v_lshrrev_b32 v5, 1, v4
    v_lshlrev_b32 v5, 14, v5
    v_mfma_f32_16x16x32_bf16 a[20:23], v[122:125], a[128:131], a[20:23]
    buffer_load_dwordx4 v66, s[96:99], s61 offen offset:2048 lds
    v_mfma_f32_16x16x32_bf16 a[20:23], v[126:129], a[132:135], a[20:23]
    ds_read_b128 a[184:187], v29 offset:512
    v_alignbit_b32 v169, v115, v110, 16
    v_mfma_f32_16x16x32_bf16 a[20:23], v[130:133], a[148:151], a[20:23]
    ds_read_b128 a[188:191], v28 offset:512
    v_bfi_b32 v173, s55, v111, v115
    v_mfma_f32_16x16x32_bf16 a[20:23], v[134:137], a[152:155], a[20:23]
    v_lshl_add_u32 v5, v3, 4, v5
    v_and_b32 v6, 1, v4
    v_mfma_f32_16x16x32_bf16 a[20:23], v[138:141], a[156:159], a[20:23]
    v_alignbit_b32 v177, v116, v111, 16
    s_waitcnt lgkmcnt(2)
    v_mfma_f32_16x16x32_bf16 a[20:23], v[142:145], a[172:175], a[20:23]
    ds_read_b128 a[192:195], v28 offset:528
    ds_read_b128 a[196:199], v28 offset:752
    v_mfma_f32_16x16x32_bf16 a[20:23], v[146:149], a[176:179], a[20:23]
    v_bfi_b32 v181, s55, v112, v116
    v_mfma_f32_16x16x32_bf16 a[20:23], v[150:153], a[180:183], a[20:23]
    buffer_load_dwordx4 v67, s[96:99], s61 offen offset:3072 lds
    v_mfma_f32_16x16x32_bf16 a[24:27], v[118:121], a[136:139], a[24:27]
    v_lshl_add_u32 v48, v6, 8, v5
    s_lshl_b32 s68, s47, 20
    v_mfma_f32_16x16x32_bf16 a[24:27], v[122:125], a[140:143], a[24:27]
    v_alignbit_b32 v185, v117, v112, 16
    ds_read_b128 a[200:203], v28 offset:768
    v_mfma_f32_16x16x32_bf16 a[24:27], v[126:129], a[144:147], a[24:27]
    v_bfi_b32 v189, s55, v113, v117
    ds_read_b128 a[204:207], v30 offset:784
    v_mfma_f32_16x16x32_bf16 a[24:27], v[130:133], a[160:163], a[24:27]
    s_lshl_b32 s69, s51, 11
    s_add_u32 s68, s68, s69
    v_mfma_f32_16x16x32_bf16 a[24:27], v[134:137], a[164:167], a[24:27]
    s_add_u32 m0, s53, 14336
    v_mfma_f32_16x16x32_bf16 a[24:27], v[138:141], a[168:171], a[24:27]
    s_waitcnt lgkmcnt(3)
    v_mfma_f32_16x16x32_bf16 a[24:27], v[142:145], a[184:187], a[24:27]
    buffer_load_dwordx4 v68, s[96:99], s61 offen offset:0 lds
    v_mfma_f32_16x16x32_bf16 a[24:27], v[146:149], a[188:191], a[24:27]
    s_add_u32 s69, s52, s44
    s_lshl_b32 s69, s69, 9
    v_mfma_f32_16x16x32_bf16 a[24:27], v[150:153], a[192:195], a[24:27]
    s_waitcnt vmcnt(11)
    ds_read_b128 v[82:85], v74 offset:0
    v_mfma_f32_16x16x32_bf16 a[28:31], v[118:121], a[148:151], a[28:31]
    ds_read_b128 v[86:89], v75 offset:0
    v_mfma_f32_16x16x32_bf16 a[28:31], v[122:125], a[152:155], a[28:31]
    s_add_u32 s88, s68, s69
    s_add_u32 s88, s88, 4259840
    v_mfma_f32_16x16x32_bf16 a[28:31], v[126:129], a[156:159], a[28:31]
    buffer_load_dwordx4 v69, s[96:99], s61 offen offset:1024 lds
    v_mfma_f32_16x16x32_bf16 a[28:31], v[130:133], a[172:175], a[28:31]
    ds_read_b128 v[90:93], v76 offset:0
    s_add_u32 s89, s88, 32768
    v_mfma_f32_16x16x32_bf16 a[28:31], v[134:137], a[176:179], a[28:31]
    ds_read_b128 v[94:97], v77 offset:0
    ds_read_b128 v[98:101], v74 offset:1024
    v_mfma_f32_16x16x32_bf16 a[28:31], v[138:141], a[180:183], a[28:31]
    s_waitcnt lgkmcnt(5)
    v_mfma_f32_16x16x32_bf16 a[28:31], v[142:145], a[196:199], a[28:31]
    buffer_load_dwordx4 v70, s[96:99], s61 offen offset:2048 lds
    v_mfma_f32_16x16x32_bf16 a[28:31], v[146:149], a[200:203], a[28:31]
    ds_read_b128 v[102:105], v75 offset:1024
    ds_read_b128 v[106:109], v76 offset:1024
    v_mfma_f32_16x16x32_bf16 a[28:31], v[150:153], a[204:207], a[28:31]
    buffer_load_dwordx4 v71, s[96:99], s61 offen offset:3072 lds
    v_mfma_f32_16x16x32_bf16 a[32:35], v[154:157], a[64:67], a[32:35]
    ds_read_b128 v[110:113], v77 offset:1024
    ds_read_b128 v[114:117], v74 offset:2048
    v_mfma_f32_16x16x32_bf16 a[32:35], v[158:161], a[68:71], a[32:35]
    s_add_u32 m0, s53, 18432
    v_mfma_f32_16x16x32_bf16 a[32:35], v[162:165], a[72:75], a[32:35]
    buffer_load_dwordx4 v72, s[96:99], s61 offen offset:0 lds
    v_mfma_f32_16x16x32_bf16 a[32:35], v[166:169], a[88:91], a[32:35]
    s_waitcnt lgkmcnt(6)
    v_bfi_b32 v118, s55, v82, v86
    v_mfma_f32_16x16x32_bf16 a[32:35], v[170:173], a[92:95], a[32:35]
    v_alignbit_b32 v122, v87, v82, 16
    v_bfi_b32 v126, s55, v83, v87
    v_mfma_f32_16x16x32_bf16 a[32:35], v[174:177], a[96:99], a[32:35]
    buffer_load_dwordx4 v73, s[96:99], s61 offen offset:1024 lds
    v_mfma_f32_16x16x32_bf16 a[32:35], v[178:181], a[112:115], a[32:35]
    v_alignbit_b32 v130, v88, v83, 16
    v_bfi_b32 v134, s55, v84, v88
    v_mfma_f32_16x16x32_bf16 a[32:35], v[182:185], a[116:119], a[32:35]
    v_alignbit_b32 v138, v89, v84, 16
    s_add_u32 m0, s53, 28672
    v_mfma_f32_16x16x32_bf16 a[32:35], v[186:189], a[120:123], a[32:35]
    buffer_load_dwordx4 v20, s[28:31], s77 offen offset:0 lds
    v_mfma_f32_16x16x32_bf16 a[36:39], v[154:157], a[76:79], a[36:39]
    v_bfi_b32 v142, s55, v85, v89
    v_mfma_f32_16x16x32_bf16 a[36:39], v[158:161], a[80:83], a[36:39]
    v_alignbit_b32 v146, v90, v85, 16
    v_mfma_f32_16x16x32_bf16 a[36:39], v[162:165], a[84:87], a[36:39]
    v_bfi_b32 v150, s55, v86, v90
    v_mfma_f32_16x16x32_bf16 a[36:39], v[166:169], a[100:103], a[36:39]
    v_mfma_f32_16x16x32_bf16 a[36:39], v[170:173], a[104:107], a[36:39]
    s_waitcnt lgkmcnt(4)
    v_bfi_b32 v119, s55, v91, v95
    v_mfma_f32_16x16x32_bf16 a[36:39], v[174:177], a[108:111], a[36:39]
    buffer_load_dwordx4 v21, s[28:31], s77 offen offset:1024 lds
    v_mfma_f32_16x16x32_bf16 a[36:39], v[178:181], a[124:127], a[36:39]
    v_alignbit_b32 v123, v96, v91, 16
    v_bfi_b32 v127, s55, v92, v96
    v_mfma_f32_16x16x32_bf16 a[36:39], v[182:185], a[128:131], a[36:39]
    v_mfma_f32_16x16x32_bf16 a[36:39], v[186:189], a[132:135], a[36:39]
    v_alignbit_b32 v131, v97, v92, 16
    v_mfma_f32_16x16x32_bf16 a[40:43], v[154:157], a[88:91], a[40:43]
    v_bfi_b32 v135, s55, v93, v97
    v_mfma_f32_16x16x32_bf16 a[40:43], v[158:161], a[92:95], a[40:43]
    buffer_load_dwordx4 v22, s[28:31], s77 offen offset:2048 lds
    v_mfma_f32_16x16x32_bf16 a[40:43], v[162:165], a[96:99], a[40:43]
    s_waitcnt vmcnt(15)
    ds_read_b128 a[64:67], v29 offset:4096
    v_mfma_f32_16x16x32_bf16 a[40:43], v[166:169], a[112:115], a[40:43]
    v_alignbit_b32 v139, v98, v93, 16
    ds_read_b128 a[68:71], v28 offset:4096
    v_mfma_f32_16x16x32_bf16 a[40:43], v[170:173], a[116:119], a[40:43]
    v_bfi_b32 v143, s55, v94, v98
    ds_read_b128 a[72:75], v28 offset:4112
    v_mfma_f32_16x16x32_bf16 a[40:43], v[174:177], a[120:123], a[40:43]
    v_alignbit_b32 v147, v99, v94, 16
    ds_read_b128 a[76:79], v28 offset:4336
    v_mfma_f32_16x16x32_bf16 a[40:43], v[178:181], a[136:139], a[40:43]
    v_bfi_b32 v151, s55, v95, v99
    v_mfma_f32_16x16x32_bf16 a[40:43], v[182:185], a[140:143], a[40:43]
    buffer_load_dwordx4 v23, s[28:31], s77 offen offset:3072 lds
    v_mfma_f32_16x16x32_bf16 a[40:43], v[186:189], a[144:147], a[40:43]
    ds_read_b128 a[80:83], v28 offset:4352
    v_mfma_f32_16x16x32_bf16 a[44:47], v[154:157], a[100:103], a[44:47]
    s_waitcnt lgkmcnt(7)
    v_bfi_b32 v120, s55, v100, v104
    v_mfma_f32_16x16x32_bf16 a[44:47], v[158:161], a[104:107], a[44:47]
    ds_read_b128 a[84:87], v30 offset:4368
    v_alignbit_b32 v124, v105, v100, 16
    v_mfma_f32_16x16x32_bf16 a[44:47], v[162:165], a[108:111], a[44:47]
    v_bfi_b32 v128, s55, v101, v105
    s_add_u32 m0, s53, 32768
    v_mfma_f32_16x16x32_bf16 a[44:47], v[166:169], a[124:127], a[44:47]
    buffer_load_dwordx4 v24, s[28:31], s77 offen offset:0 lds
    v_mfma_f32_16x16x32_bf16 a[44:47], v[170:173], a[128:131], a[44:47]
    v_alignbit_b32 v132, v106, v101, 16
    v_bfi_b32 v136, s55, v102, v106
    v_mfma_f32_16x16x32_bf16 a[44:47], v[174:177], a[132:135], a[44:47]
    v_alignbit_b32 v140, v107, v102, 16
    v_mfma_f32_16x16x32_bf16 a[44:47], v[178:181], a[148:151], a[44:47]
    v_bfi_b32 v144, s55, v103, v107
    v_mfma_f32_16x16x32_bf16 a[44:47], v[182:185], a[152:155], a[44:47]
    buffer_load_dwordx4 v25, s[28:31], s77 offen offset:1024 lds
    v_mfma_f32_16x16x32_bf16 a[44:47], v[186:189], a[156:159], a[44:47]
    v_alignbit_b32 v148, v108, v103, 16
    v_bfi_b32 v152, s55, v104, v108
    v_mfma_f32_16x16x32_bf16 a[48:51], v[154:157], a[112:115], a[48:51]
    v_mfma_f32_16x16x32_bf16 a[48:51], v[158:161], a[116:119], a[48:51]
    ds_read_b128 a[88:91], v29 offset:4608
    v_mfma_f32_16x16x32_bf16 a[48:51], v[162:165], a[120:123], a[48:51]
    s_waitcnt lgkmcnt(7)
    v_bfi_b32 v121, s55, v109, v113
    v_mfma_f32_16x16x32_bf16 a[48:51], v[166:169], a[136:139], a[48:51]
    ds_read_b128 a[92:95], v28 offset:4608
    v_alignbit_b32 v125, v114, v109, 16
    v_mfma_f32_16x16x32_bf16 a[48:51], v[170:173], a[140:143], a[48:51]
    buffer_load_dwordx4 v26, s[28:31], s77 offen offset:2048 lds
    v_mfma_f32_16x16x32_bf16 a[48:51], v[174:177], a[144:147], a[48:51]
    v_bfi_b32 v129, s55, v110, v114
    ds_read_b128 a[96:99], v28 offset:4624
    v_mfma_f32_16x16x32_bf16 a[48:51], v[178:181], a[160:163], a[48:51]
    ds_read_b128 a[100:103], v28 offset:4848
    v_alignbit_b32 v133, v115, v110, 16
    v_mfma_f32_16x16x32_bf16 a[48:51], v[182:185], a[164:167], a[48:51]
    v_bfi_b32 v137, s55, v111, v115
    ds_read_b128 a[104:107], v28 offset:4864
    v_mfma_f32_16x16x32_bf16 a[48:51], v[186:189], a[168:171], a[48:51]
    v_alignbit_b32 v141, v116, v111, 16
    v_mfma_f32_16x16x32_bf16 a[52:55], v[154:157], a[124:127], a[52:55]
    buffer_load_dwordx4 v27, s[28:31], s77 offen offset:3072 lds
    v_mfma_f32_16x16x32_bf16 a[52:55], v[158:161], a[128:131], a[52:55]
    ds_read_b128 a[108:111], v30 offset:4880
    v_bfi_b32 v145, s55, v112, v116
    v_mfma_f32_16x16x32_bf16 a[52:55], v[162:165], a[132:135], a[52:55]
    v_alignbit_b32 v149, v117, v112, 16
    v_bfi_b32 v153, s55, v113, v117
    v_mfma_f32_16x16x32_bf16 a[52:55], v[166:169], a[148:151], a[52:55]
    s_add_u32 m0, s53, 0
    v_mfma_f32_16x16x32_bf16 a[52:55], v[170:173], a[152:155], a[52:55]
    buffer_load_dwordx4 v65, s[96:99], s62 offen offset:1024 lds
    v_mfma_f32_16x16x32_bf16 a[52:55], v[174:177], a[156:159], a[52:55]
    v_mfma_f32_16x16x32_bf16 a[52:55], v[178:181], a[172:175], a[52:55]
    v_mfma_f32_16x16x32_bf16 a[52:55], v[182:185], a[176:179], a[52:55]
    s_waitcnt vmcnt(9)
    ds_read_b128 v[82:85], v74 offset:10240
    v_mfma_f32_16x16x32_bf16 a[52:55], v[186:189], a[180:183], a[52:55]
    buffer_load_dwordx4 v66, s[96:99], s62 offen offset:2048 lds
    v_mfma_f32_16x16x32_bf16 a[56:59], v[154:157], a[136:139], a[56:59]
    ds_read_b128 v[86:89], v75 offset:10240
    v_mfma_f32_16x16x32_bf16 a[56:59], v[158:161], a[140:143], a[56:59]
    s_waitcnt vmcnt(6)
    ds_read_b128 a[112:115], v29 offset:8192
    v_mfma_f32_16x16x32_bf16 a[56:59], v[162:165], a[144:147], a[56:59]
    ds_read_b128 a[116:119], v28 offset:8192
    ds_read_b128 v[90:93], v76 offset:10240
    v_mfma_f32_16x16x32_bf16 a[56:59], v[166:169], a[160:163], a[56:59]
    v_mfma_f32_16x16x32_bf16 a[56:59], v[170:173], a[164:167], a[56:59]
    ds_read_b128 a[120:123], v28 offset:8208
    ds_read_b128 v[94:97], v77 offset:10240
    v_mfma_f32_16x16x32_bf16 a[56:59], v[174:177], a[168:171], a[56:59]
    buffer_load_dwordx4 v67, s[96:99], s62 offen offset:3072 lds
    v_mfma_f32_16x16x32_bf16 a[56:59], v[178:181], a[184:187], a[56:59]
    ds_read_b128 a[124:127], v28 offset:8432
    ds_read_b128 v[98:101], v74 offset:11264
    v_mfma_f32_16x16x32_bf16 a[56:59], v[182:185], a[188:191], a[56:59]
    ds_read_b128 a[128:131], v28 offset:8448
    v_mfma_f32_16x16x32_bf16 a[56:59], v[186:189], a[192:195], a[56:59]
    ds_read_b128 a[132:135], v30 offset:8464
    ds_read_b128 v[102:105], v75 offset:11264
    v_mfma_f32_16x16x32_bf16 a[60:63], v[154:157], a[148:151], a[60:63]
    s_add_u32 m0, s53, 4096
    v_mfma_f32_16x16x32_bf16 a[60:63], v[158:161], a[152:155], a[60:63]
    buffer_load_dwordx4 v68, s[96:99], s62 offen offset:0 lds
    v_mfma_f32_16x16x32_bf16 a[60:63], v[162:165], a[156:159], a[60:63]
    ds_read_b128 v[106:109], v76 offset:11264
    v_mfma_f32_16x16x32_bf16 a[60:63], v[166:169], a[172:175], a[60:63]
    ds_read_b128 v[110:113], v77 offset:11264
    v_mfma_f32_16x16x32_bf16 a[60:63], v[170:173], a[176:179], a[60:63]
    v_mfma_f32_16x16x32_bf16 a[60:63], v[174:177], a[180:183], a[60:63]
    ds_read_b128 v[114:117], v74 offset:12288
    v_mfma_f32_16x16x32_bf16 a[60:63], v[178:181], a[196:199], a[60:63]
    buffer_load_dwordx4 v69, s[96:99], s62 offen offset:1024 lds
    v_mfma_f32_16x16x32_bf16 a[60:63], v[182:185], a[200:203], a[60:63]
    v_mfma_f32_16x16x32_bf16 a[60:63], v[186:189], a[204:207], a[60:63]
    s_waitcnt lgkmcnt(15)
    v_mfma_f32_16x16x32_bf16 a[0:3], v[118:121], a[64:67], a[0:3]
    v_mfma_f32_16x16x32_bf16 a[0:3], v[122:125], a[68:71], a[0:3]
    ds_read_b128 a[136:139], v29 offset:8704
    v_mfma_f32_16x16x32_bf16 a[0:3], v[126:129], a[72:75], a[0:3]
    s_waitcnt lgkmcnt(11)
    v_bfi_b32 v154, s55, v82, v86
    v_mfma_f32_16x16x32_bf16 a[0:3], v[130:133], a[88:91], a[0:3]
    buffer_load_dwordx4 v70, s[96:99], s62 offen offset:2048 lds
    v_mfma_f32_16x16x32_bf16 a[0:3], v[134:137], a[92:95], a[0:3]
    ds_read_b128 a[140:143], v28 offset:8704
    v_alignbit_b32 v158, v87, v82, 16
    v_mfma_f32_16x16x32_bf16 a[0:3], v[138:141], a[96:99], a[0:3]
    v_bfi_b32 v162, s55, v83, v87
    s_waitcnt lgkmcnt(11)
    v_mfma_f32_16x16x32_bf16 a[0:3], v[142:145], a[112:115], a[0:3]
    ds_read_b128 a[144:147], v28 offset:8720
    ds_read_b128 a[148:151], v28 offset:8944
    v_mfma_f32_16x16x32_bf16 a[0:3], v[146:149], a[116:119], a[0:3]
    v_alignbit_b32 v166, v88, v83, 16
    v_bfi_b32 v170, s55, v84, v88
    v_mfma_f32_16x16x32_bf16 a[0:3], v[150:153], a[120:123], a[0:3]
    buffer_load_dwordx4 v71, s[96:99], s62 offen offset:3072 lds
    v_mfma_f32_16x16x32_bf16 a[4:7], v[118:121], a[76:79], a[4:7]
    ds_read_b128 a[152:155], v28 offset:8960
    v_alignbit_b32 v174, v89, v84, 16
    v_mfma_f32_16x16x32_bf16 a[4:7], v[122:125], a[80:83], a[4:7]
    ds_read_b128 a[156:159], v30 offset:8976
    v_bfi_b32 v178, s55, v85, v89
    v_mfma_f32_16x16x32_bf16 a[4:7], v[126:129], a[84:87], a[4:7]
    v_alignbit_b32 v182, v90, v85, 16
    s_add_u32 m0, s53, 8192
    v_mfma_f32_16x16x32_bf16 a[4:7], v[130:133], a[100:103], a[4:7]
    v_bfi_b32 v186, s55, v86, v90
    v_mfma_f32_16x16x32_bf16 a[4:7], v[134:137], a[104:107], a[4:7]
    buffer_load_dwordx4 v72, s[96:99], s62 offen offset:0 lds
    v_mfma_f32_16x16x32_bf16 a[4:7], v[138:141], a[108:111], a[4:7]
    v_add_f32_dpp v32, v32, v32 quad_perm:[1,0,3,2] row_mask:0xf bank_mask:0xf
    s_waitcnt lgkmcnt(10)
    v_mfma_f32_16x16x32_bf16 a[4:7], v[142:145], a[124:127], a[4:7]
    v_bfi_b32 v155, s55, v91, v95
    v_alignbit_b32 v159, v96, v91, 16
    v_mfma_f32_16x16x32_bf16 a[4:7], v[146:149], a[128:131], a[4:7]
    v_add_f32_dpp v33, v33, v33 quad_perm:[1,0,3,2] row_mask:0xf bank_mask:0xf
    v_bfi_b32 v163, s55, v92, v96
    v_mfma_f32_16x16x32_bf16 a[4:7], v[150:153], a[132:135], a[4:7]
    s_add_u32 m0, s53, 36864
    s_add_u32 s77, s67, 65536
    v_mfma_f32_16x16x32_bf16 a[8:11], v[118:121], a[88:91], a[8:11]
    buffer_load_dwordx4 v16, s[28:31], s77 offen offset:0 lds
    v_mfma_f32_16x16x32_bf16 a[8:11], v[122:125], a[92:95], a[8:11]
    v_add_f32_dpp v34, v34, v34 quad_perm:[1,0,3,2] row_mask:0xf bank_mask:0xf
    v_alignbit_b32 v167, v97, v92, 16
    v_mfma_f32_16x16x32_bf16 a[8:11], v[126:129], a[96:99], a[8:11]
    v_bfi_b32 v171, s55, v93, v97
    v_add_f32_dpp v35, v35, v35 quad_perm:[1,0,3,2] row_mask:0xf bank_mask:0xf
    v_mfma_f32_16x16x32_bf16 a[8:11], v[130:133], a[112:115], a[8:11]
    v_alignbit_b32 v175, v98, v93, 16
    v_add_f32_dpp v36, v36, v36 quad_perm:[1,0,3,2] row_mask:0xf bank_mask:0xf
    v_mfma_f32_16x16x32_bf16 a[8:11], v[134:137], a[116:119], a[8:11]
    v_bfi_b32 v179, s55, v94, v98
    v_mfma_f32_16x16x32_bf16 a[8:11], v[138:141], a[120:123], a[8:11]
    s_waitcnt lgkmcnt(3)
    v_mfma_f32_16x16x32_bf16 a[8:11], v[142:145], a[136:139], a[8:11]
    buffer_load_dwordx4 v17, s[28:31], s77 offen offset:1024 lds
    v_mfma_f32_16x16x32_bf16 a[8:11], v[146:149], a[140:143], a[8:11]
    v_alignbit_b32 v183, v99, v94, 16
    v_add_f32_dpp v37, v37, v37 quad_perm:[1,0,3,2] row_mask:0xf bank_mask:0xf
    v_mfma_f32_16x16x32_bf16 a[8:11], v[150:153], a[144:147], a[8:11]
    s_waitcnt vmcnt(10)
    ds_read_b128 a[160:163], v29 offset:12288
    v_mfma_f32_16x16x32_bf16 a[12:15], v[118:121], a[100:103], a[12:15]
    v_bfi_b32 v187, s55, v95, v99
    ds_read_b128 a[164:167], v28 offset:12288
    v_mfma_f32_16x16x32_bf16 a[12:15], v[122:125], a[104:107], a[12:15]
    v_add_f32_dpp v38, v38, v38 quad_perm:[1,0,3,2] row_mask:0xf bank_mask:0xf
    v_bfi_b32 v156, s55, v100, v104
    v_mfma_f32_16x16x32_bf16 a[12:15], v[126:129], a[108:111], a[12:15]
    ds_read_b128 a[168:171], v28 offset:12304
    v_alignbit_b32 v160, v105, v100, 16
    v_mfma_f32_16x16x32_bf16 a[12:15], v[130:133], a[124:127], a[12:15]
    buffer_load_dwordx4 v18, s[28:31], s77 offen offset:2048 lds
    v_mfma_f32_16x16x32_bf16 a[12:15], v[134:137], a[128:131], a[12:15]
    v_add_f32_dpp v39, v39, v39 quad_perm:[1,0,3,2] row_mask:0xf bank_mask:0xf
    ds_read_b128 a[172:175], v28 offset:12528
    v_mfma_f32_16x16x32_bf16 a[12:15], v[138:141], a[132:135], a[12:15]
    v_bfi_b32 v164, s55, v101, v105
    s_waitcnt lgkmcnt(4)
    v_mfma_f32_16x16x32_bf16 a[12:15], v[142:145], a[148:151], a[12:15]
    v_add_f32_dpp v32, v32, v32 quad_perm:[2,3,0,1] row_mask:0xf bank_mask:0xf
    ds_read_b128 a[176:179], v28 offset:12544
    v_mfma_f32_16x16x32_bf16 a[12:15], v[146:149], a[152:155], a[12:15]
    v_alignbit_b32 v168, v106, v101, 16
    ds_read_b128 a[180:183], v30 offset:12560
    v_mfma_f32_16x16x32_bf16 a[12:15], v[150:153], a[156:159], a[12:15]
    v_bfi_b32 v172, s55, v102, v106
    v_add_f32_dpp v33, v33, v33 quad_perm:[2,3,0,1] row_mask:0xf bank_mask:0xf
    v_mfma_f32_16x16x32_bf16 a[16:19], v[118:121], a[112:115], a[16:19]
    v_alignbit_b32 v176, v107, v102, 16
    v_mfma_f32_16x16x32_bf16 a[16:19], v[122:125], a[116:119], a[16:19]
    buffer_load_dwordx4 v19, s[28:31], s77 offen offset:3072 lds
    v_mfma_f32_16x16x32_bf16 a[16:19], v[126:129], a[120:123], a[16:19]
    v_add_f32_dpp v34, v34, v34 quad_perm:[2,3,0,1] row_mask:0xf bank_mask:0xf
    v_bfi_b32 v180, s55, v103, v107
    v_mfma_f32_16x16x32_bf16 a[16:19], v[130:133], a[136:139], a[16:19]
    v_alignbit_b32 v184, v108, v103, 16
    v_add_f32_dpp v35, v35, v35 quad_perm:[2,3,0,1] row_mask:0xf bank_mask:0xf
    v_mfma_f32_16x16x32_bf16 a[16:19], v[134:137], a[140:143], a[16:19]
    v_bfi_b32 v188, s55, v104, v108
    s_add_u32 m0, s53, 10240
    v_mfma_f32_16x16x32_bf16 a[16:19], v[138:141], a[144:147], a[16:19]
    s_waitcnt lgkmcnt(3)
    v_mfma_f32_16x16x32_bf16 a[16:19], v[142:145], a[160:163], a[16:19]
    buffer_load_dwordx4 v65, s[96:99], s63 offen offset:1024 lds
    v_mfma_f32_16x16x32_bf16 a[16:19], v[146:149], a[164:167], a[16:19]
    v_add_f32_dpp v36, v36, v36 quad_perm:[2,3,0,1] row_mask:0xf bank_mask:0xf
    v_bfi_b32 v157, s55, v109, v113
    v_mfma_f32_16x16x32_bf16 a[16:19], v[150:153], a[168:171], a[16:19]
    v_alignbit_b32 v161, v114, v109, 16
    v_add_f32_dpp v37, v37, v37 quad_perm:[2,3,0,1] row_mask:0xf bank_mask:0xf
    v_mfma_f32_16x16x32_bf16 a[20:23], v[118:121], a[124:127], a[20:23]
    v_bfi_b32 v165, s55, v110, v114
    v_add_f32_dpp v38, v38, v38 quad_perm:[2,3,0,1] row_mask:0xf bank_mask:0xf
    v_mfma_f32_16x16x32_bf16 a[20:23], v[122:125], a[128:131], a[20:23]
    ds_read_b128 a[184:187], v29 offset:12800
    v_alignbit_b32 v169, v115, v110, 16
    v_mfma_f32_16x16x32_bf16 a[20:23], v[126:129], a[132:135], a[20:23]
    buffer_load_dwordx4 v66, s[96:99], s63 offen offset:2048 lds
    v_mfma_f32_16x16x32_bf16 a[20:23], v[130:133], a[148:151], a[20:23]
    ds_read_b128 a[188:191], v28 offset:12800
    v_bfi_b32 v173, s55, v111, v115
    v_mfma_f32_16x16x32_bf16 a[20:23], v[134:137], a[152:155], a[20:23]
    v_add_f32_dpp v39, v39, v39 quad_perm:[2,3,0,1] row_mask:0xf bank_mask:0xf
    v_alignbit_b32 v177, v116, v111, 16
    v_mfma_f32_16x16x32_bf16 a[20:23], v[138:141], a[156:159], a[20:23]
    ds_read_b128 a[192:195], v28 offset:12816
    s_waitcnt lgkmcnt(3)
    v_mfma_f32_16x16x32_bf16 a[20:23], v[142:145], a[172:175], a[20:23]
    v_add_f32_dpp v32, v32, v32 row_half_mirror row_mask:0xf bank_mask:0xf
    ds_read_b128 a[196:199], v28 offset:13040
    v_mfma_f32_16x16x32_bf16 a[20:23], v[146:149], a[176:179], a[20:23]
    v_bfi_b32 v181, s55, v112, v116
    v_alignbit_b32 v185, v117, v112, 16
    v_mfma_f32_16x16x32_bf16 a[20:23], v[150:153], a[180:183], a[20:23]
    buffer_load_dwordx4 v67, s[96:99], s63 offen offset:3072 lds
    v_mfma_f32_16x16x32_bf16 a[24:27], v[118:121], a[136:139], a[24:27]
    v_add_f32_dpp v33, v33, v33 row_half_mirror row_mask:0xf bank_mask:0xf
    ds_read_b128 a[200:203], v28 offset:13056
    v_mfma_f32_16x16x32_bf16 a[24:27], v[122:125], a[140:143], a[24:27]
    v_bfi_b32 v189, s55, v113, v117
    ds_read_b128 a[204:207], v30 offset:13072
    v_mfma_f32_16x16x32_bf16 a[24:27], v[126:129], a[144:147], a[24:27]
    v_add_f32_dpp v34, v34, v34 row_half_mirror row_mask:0xf bank_mask:0xf
    s_add_u32 m0, s53, 14336
    v_mfma_f32_16x16x32_bf16 a[24:27], v[130:133], a[160:163], a[24:27]
    v_add_f32_dpp v35, v35, v35 row_half_mirror row_mask:0xf bank_mask:0xf
    v_mfma_f32_16x16x32_bf16 a[24:27], v[134:137], a[164:167], a[24:27]
    buffer_load_dwordx4 v68, s[96:99], s63 offen offset:0 lds
    v_mfma_f32_16x16x32_bf16 a[24:27], v[138:141], a[168:171], a[24:27]
    s_waitcnt lgkmcnt(3)
    v_mfma_f32_16x16x32_bf16 a[24:27], v[142:145], a[184:187], a[24:27]
    s_waitcnt vmcnt(8)
    ds_read_b128 v[82:85], v78 offset:0
    v_mfma_f32_16x16x32_bf16 a[24:27], v[146:149], a[188:191], a[24:27]
    v_add_f32_dpp v36, v36, v36 row_half_mirror row_mask:0xf bank_mask:0xf
    ds_read_b128 v[86:89], v79 offset:0
    v_mfma_f32_16x16x32_bf16 a[24:27], v[150:153], a[192:195], a[24:27]
    v_add_f32_dpp v37, v37, v37 row_half_mirror row_mask:0xf bank_mask:0xf
    ds_read_b128 v[90:93], v80 offset:0
    v_mfma_f32_16x16x32_bf16 a[28:31], v[118:121], a[148:151], a[28:31]
    buffer_load_dwordx4 v69, s[96:99], s63 offen offset:1024 lds
    v_mfma_f32_16x16x32_bf16 a[28:31], v[122:125], a[152:155], a[28:31]
    v_add_f32_dpp v38, v38, v38 row_half_mirror row_mask:0xf bank_mask:0xf
    ds_read_b128 v[94:97], v81 offset:0
    v_mfma_f32_16x16x32_bf16 a[28:31], v[126:129], a[156:159], a[28:31]
    v_add_f32_dpp v39, v39, v39 row_half_mirror row_mask:0xf bank_mask:0xf
    ds_read_b128 v[98:101], v74 offset:1024
    v_mfma_f32_16x16x32_bf16 a[28:31], v[130:133], a[172:175], a[28:31]
    v_add_f32_dpp v32, v32, v32 row_mirror row_mask:0xf bank_mask:0xf
    v_mfma_f32_16x16x32_bf16 a[28:31], v[134:137], a[176:179], a[28:31]
    buffer_load_dwordx4 v70, s[96:99], s63 offen offset:2048 lds
    v_mfma_f32_16x16x32_bf16 a[28:31], v[138:141], a[180:183], a[28:31]
    ds_read_b128 v[102:105], v75 offset:1024
    s_waitcnt lgkmcnt(6)
    v_mfma_f32_16x16x32_bf16 a[28:31], v[142:145], a[196:199], a[28:31]
    v_add_f32_dpp v33, v33, v33 row_mirror row_mask:0xf bank_mask:0xf
    ds_read_b128 v[106:109], v76 offset:1024
    v_mfma_f32_16x16x32_bf16 a[28:31], v[146:149], a[200:203], a[28:31]
    v_add_f32_dpp v34, v34, v34 row_mirror row_mask:0xf bank_mask:0xf
    ds_read_b128 v[110:113], v77 offset:1024
    v_mfma_f32_16x16x32_bf16 a[28:31], v[150:153], a[204:207], a[28:31]
    buffer_load_dwordx4 v71, s[96:99], s63 offen offset:3072 lds
    v_mfma_f32_16x16x32_bf16 a[32:35], v[154:157], a[64:67], a[32:35]
    v_add_f32_dpp v35, v35, v35 row_mirror row_mask:0xf bank_mask:0xf
    ds_read_b128 v[114:117], v74 offset:2048
    v_mfma_f32_16x16x32_bf16 a[32:35], v[158:161], a[68:71], a[32:35]
    v_add_f32_dpp v36, v36, v36 row_mirror row_mask:0xf bank_mask:0xf
    s_add_u32 m0, s53, 18432
    v_mfma_f32_16x16x32_bf16 a[32:35], v[162:165], a[72:75], a[32:35]
    v_add_f32_dpp v37, v37, v37 row_mirror row_mask:0xf bank_mask:0xf
    v_mfma_f32_16x16x32_bf16 a[32:35], v[166:169], a[88:91], a[32:35]
    buffer_load_dwordx4 v72, s[96:99], s63 offen offset:0 lds
    v_mfma_f32_16x16x32_bf16 a[32:35], v[170:173], a[92:95], a[32:35]
    v_add_f32_dpp v38, v38, v38 row_mirror row_mask:0xf bank_mask:0xf
    v_mfma_f32_16x16x32_bf16 a[32:35], v[174:177], a[96:99], a[32:35]
    s_waitcnt lgkmcnt(6)
    v_bfi_b32 v118, s55, v82, v86
    v_mfma_f32_16x16x32_bf16 a[32:35], v[178:181], a[112:115], a[32:35]
    v_alignbit_b32 v122, v87, v82, 16
    v_add_f32_dpp v39, v39, v39 row_mirror row_mask:0xf bank_mask:0xf
    v_mfma_f32_16x16x32_bf16 a[32:35], v[182:185], a[116:119], a[32:35]
    v_bfi_b32 v126, s55, v83, v87
    s_add_u32 m0, s53, 20480
    v_mfma_f32_16x16x32_bf16 a[32:35], v[186:189], a[120:123], a[32:35]
    buffer_load_dwordx4 v20, s[28:31], s77 offen offset:0 lds
    v_mfma_f32_16x16x32_bf16 a[36:39], v[154:157], a[76:79], a[36:39]
    v_lshlrev_b32 v194, 16, v40
    v_alignbit_b32 v130, v88, v83, 16
    v_mfma_f32_16x16x32_bf16 a[36:39], v[158:161], a[80:83], a[36:39]
    v_bfi_b32 v134, s55, v84, v88
    v_lshlrev_b32 v202, 16, v44
    v_mfma_f32_16x16x32_bf16 a[36:39], v[162:165], a[84:87], a[36:39]
    v_alignbit_b32 v138, v89, v84, 16
    v_and_b32 v195, 0xffff0000, v40
    v_mfma_f32_16x16x32_bf16 a[36:39], v[166:169], a[100:103], a[36:39]
    v_bfi_b32 v142, s55, v85, v89
    v_mfma_f32_16x16x32_bf16 a[36:39], v[170:173], a[104:107], a[36:39]
    buffer_load_dwordx4 v21, s[28:31], s77 offen offset:1024 lds
    v_mfma_f32_16x16x32_bf16 a[36:39], v[174:177], a[108:111], a[36:39]
    v_alignbit_b32 v146, v90, v85, 16
    v_and_b32 v203, 0xffff0000, v44
    v_mfma_f32_16x16x32_bf16 a[36:39], v[178:181], a[124:127], a[36:39]
    v_bfi_b32 v150, s55, v86, v90
    v_lshlrev_b32 v196, 16, v41
    v_mfma_f32_16x16x32_bf16 a[36:39], v[182:185], a[128:131], a[36:39]
    s_waitcnt lgkmcnt(4)
    v_bfi_b32 v119, s55, v91, v95
    v_mfma_f32_16x16x32_bf16 a[36:39], v[186:189], a[132:135], a[36:39]
    v_alignbit_b32 v123, v96, v91, 16
    v_mfma_f32_16x16x32_bf16 a[40:43], v[154:157], a[88:91], a[40:43]
    buffer_load_dwordx4 v22, s[28:31], s77 offen offset:2048 lds
    v_mfma_f32_16x16x32_bf16 a[40:43], v[158:161], a[92:95], a[40:43]
    v_lshlrev_b32 v204, 16, v45
    v_bfi_b32 v127, s55, v92, v96
    v_mfma_f32_16x16x32_bf16 a[40:43], v[162:165], a[96:99], a[40:43]
    v_and_b32 v197, 0xffff0000, v41
    v_alignbit_b32 v131, v97, v92, 16
    v_mfma_f32_16x16x32_bf16 a[40:43], v[166:169], a[112:115], a[40:43]
    v_bfi_b32 v135, s55, v93, v97
    v_and_b32 v205, 0xffff0000, v45
    v_mfma_f32_16x16x32_bf16 a[40:43], v[170:173], a[116:119], a[40:43]
    s_waitcnt vmcnt(11)
    ds_read_b128 a[64:67], v29 offset:16384
    v_mfma_f32_16x16x32_bf16 a[40:43], v[174:177], a[120:123], a[40:43]
    v_alignbit_b32 v139, v98, v93, 16
    v_mfma_f32_16x16x32_bf16 a[40:43], v[178:181], a[136:139], a[40:43]
    buffer_load_dwordx4 v23, s[28:31], s77 offen offset:3072 lds
    v_mfma_f32_16x16x32_bf16 a[40:43], v[182:185], a[140:143], a[40:43]
    ds_read_b128 a[68:71], v28 offset:16384
    v_lshlrev_b32 v198, 16, v42
    v_mfma_f32_16x16x32_bf16 a[40:43], v[186:189], a[144:147], a[40:43]
    v_bfi_b32 v143, s55, v94, v98
    ds_read_b128 a[72:75], v28 offset:16400
    v_mfma_f32_16x16x32_bf16 a[44:47], v[154:157], a[100:103], a[44:47]
    v_alignbit_b32 v147, v99, v94, 16
    v_lshlrev_b32 v206, 16, v46
    v_mfma_f32_16x16x32_bf16 a[44:47], v[158:161], a[104:107], a[44:47]
    ds_read_b128 a[76:79], v28 offset:16624
    v_bfi_b32 v151, s55, v95, v99
    v_mfma_f32_16x16x32_bf16 a[44:47], v[162:165], a[108:111], a[44:47]
    s_add_u32 m0, s53, 24576
    v_mfma_f32_16x16x32_bf16 a[44:47], v[166:169], a[124:127], a[44:47]
    buffer_load_dwordx4 v24, s[28:31], s77 offen offset:0 lds
    v_mfma_f32_16x16x32_bf16 a[44:47], v[170:173], a[128:131], a[44:47]
    v_and_b32 v199, 0xffff0000, v42
    ds_read_b128 a[80:83], v28 offset:16640
    v_mfma_f32_16x16x32_bf16 a[44:47], v[174:177], a[132:135], a[44:47]
    s_waitcnt lgkmcnt(7)
    v_bfi_b32 v120, s55, v100, v104
    v_mfma_f32_16x16x32_bf16 a[44:47], v[178:181], a[148:151], a[44:47]
    ds_read_b128 a[84:87], v30 offset:16656
    v_alignbit_b32 v124, v105, v100, 16
    v_mfma_f32_16x16x32_bf16 a[44:47], v[182:185], a[152:155], a[44:47]
    v_and_b32 v207, 0xffff0000, v46
    v_bfi_b32 v128, s55, v101, v105
    v_mfma_f32_16x16x32_bf16 a[44:47], v[186:189], a[156:159], a[44:47]
    v_lshlrev_b32 v200, 16, v43
    v_alignbit_b32 v132, v106, v101, 16
    v_mfma_f32_16x16x32_bf16 a[48:51], v[154:157], a[112:115], a[48:51]
    buffer_load_dwordx4 v25, s[28:31], s77 offen offset:1024 lds
    v_mfma_f32_16x16x32_bf16 a[48:51], v[158:161], a[116:119], a[48:51]
    v_bfi_b32 v136, s55, v102, v106
    v_lshlrev_b32 v208, 16, v47
    v_mfma_f32_16x16x32_bf16 a[48:51], v[162:165], a[120:123], a[48:51]
    v_alignbit_b32 v140, v107, v102, 16
    v_and_b32 v201, 0xffff0000, v43
    v_mfma_f32_16x16x32_bf16 a[48:51], v[166:169], a[136:139], a[48:51]
    v_bfi_b32 v144, s55, v103, v107
    v_alignbit_b32 v148, v108, v103, 16
    v_mfma_f32_16x16x32_bf16 a[48:51], v[170:173], a[140:143], a[48:51]
    buffer_load_dwordx4 v26, s[28:31], s77 offen offset:2048 lds
    v_mfma_f32_16x16x32_bf16 a[48:51], v[174:177], a[144:147], a[48:51]
    v_and_b32 v209, 0xffff0000, v47
    v_bfi_b32 v152, s55, v104, v108
    v_mfma_f32_16x16x32_bf16 a[48:51], v[178:181], a[160:163], a[48:51]
    ds_read_b128 a[88:91], v29 offset:16896
    v_mfma_f32_16x16x32_bf16 a[48:51], v[182:185], a[164:167], a[48:51]
    s_waitcnt lgkmcnt(7)
    v_bfi_b32 v121, s55, v109, v113
    v_mfma_f32_16x16x32_bf16 a[48:51], v[186:189], a[168:171], a[48:51]
    ds_read_b128 a[92:95], v28 offset:16896
    v_alignbit_b32 v125, v114, v109, 16
    v_mfma_f32_16x16x32_bf16 a[52:55], v[154:157], a[124:127], a[52:55]
    v_bfi_b32 v129, s55, v110, v114
    v_mfma_f32_16x16x32_bf16 a[52:55], v[158:161], a[128:131], a[52:55]
    buffer_load_dwordx4 v27, s[28:31], s77 offen offset:3072 lds
    v_mfma_f32_16x16x32_bf16 a[52:55], v[162:165], a[132:135], a[52:55]
    ds_read_b128 a[96:99], v28 offset:16912
    ds_read_b128 a[100:103], v28 offset:17136
    v_mfma_f32_16x16x32_bf16 a[52:55], v[166:169], a[148:151], a[52:55]
    v_alignbit_b32 v133, v115, v110, 16
    v_bfi_b32 v137, s55, v111, v115
    v_mfma_f32_16x16x32_bf16 a[52:55], v[170:173], a[152:155], a[52:55]
    ds_read_b128 a[104:107], v28 offset:17152
    v_alignbit_b32 v141, v116, v111, 16
    v_mfma_f32_16x16x32_bf16 a[52:55], v[174:177], a[156:159], a[52:55]
    s_add_u32 s96, s20, 4294963200
    s_addc_u32 s97, s21, -1
    s_and_b32 s97, s97, 0xffff
    s_mov_b32 s98, 4722688
    s_mov_b32 s99, 0x20000
    s_add_u32 m0, s53, 0
    v_mfma_f32_16x16x32_bf16 a[52:55], v[178:181], a[172:175], a[52:55]
    ds_read_b128 a[108:111], v30 offset:17168
    v_mfma_f32_16x16x32_bf16 a[52:55], v[182:185], a[176:179], a[52:55]
    buffer_load_dwordx4 v64, s[96:99], s56 offen offset:0 lds
    v_mfma_f32_16x16x32_bf16 a[52:55], v[186:189], a[180:183], a[52:55]
    v_bfi_b32 v145, s55, v112, v116
    v_alignbit_b32 v149, v117, v112, 16
    v_mfma_f32_16x16x32_bf16 a[56:59], v[154:157], a[136:139], a[56:59]
    v_bfi_b32 v153, s55, v113, v117
    v_mfma_f32_16x16x32_bf16 a[56:59], v[158:161], a[140:143], a[56:59]
    buffer_load_dwordx4 v65, s[96:99], s56 offen offset:1024 lds
    v_mfma_f32_16x16x32_bf16 a[56:59], v[162:165], a[144:147], a[56:59]
    s_waitcnt vmcnt(10)
    ds_read_b128 v[82:85], v78 offset:10240
    v_mfma_f32_16x16x32_bf16 a[56:59], v[166:169], a[160:163], a[56:59]
    ds_read_b128 v[86:89], v79 offset:10240
    v_mfma_f32_16x16x32_bf16 a[56:59], v[170:173], a[164:167], a[56:59]
    buffer_load_dwordx4 v66, s[96:99], s56 offen offset:2048 lds
    v_mfma_f32_16x16x32_bf16 a[56:59], v[174:177], a[168:171], a[56:59]
    s_waitcnt vmcnt(7)
    ds_read_b128 a[112:115], v29 offset:0
    v_mfma_f32_16x16x32_bf16 a[56:59], v[178:181], a[184:187], a[56:59]
    ds_read_b128 a[116:119], v28 offset:0
    ds_read_b128 v[90:93], v80 offset:10240
    v_mfma_f32_16x16x32_bf16 a[56:59], v[182:185], a[188:191], a[56:59]
    ds_read_b128 a[120:123], v28 offset:16
    ds_read_b128 v[94:97], v81 offset:10240
    v_mfma_f32_16x16x32_bf16 a[56:59], v[186:189], a[192:195], a[56:59]
    ds_read_b128 a[124:127], v28 offset:240
    v_mfma_f32_16x16x32_bf16 a[60:63], v[154:157], a[148:151], a[60:63]
    buffer_load_dwordx4 v67, s[96:99], s56 offen offset:3072 lds
    v_mfma_f32_16x16x32_bf16 a[60:63], v[158:161], a[152:155], a[60:63]
    ds_read_b128 v[98:101], v74 offset:11264
    ds_read_b128 a[128:131], v28 offset:256
    v_mfma_f32_16x16x32_bf16 a[60:63], v[162:165], a[156:159], a[60:63]
    ds_read_b128 a[132:135], v30 offset:272
    ds_read_b128 v[102:105], v75 offset:11264
    v_mfma_f32_16x16x32_bf16 a[60:63], v[166:169], a[172:175], a[60:63]
    s_add_u32 m0, s53, 4096
    ds_read_b128 v[106:109], v76 offset:11264
    v_mfma_f32_16x16x32_bf16 a[60:63], v[170:173], a[176:179], a[60:63]
    buffer_load_dwordx4 v68, s[96:99], s56 offen offset:0 lds
    v_mfma_f32_16x16x32_bf16 a[60:63], v[174:177], a[180:183], a[60:63]
    ds_read_b128 v[110:113], v77 offset:11264
    ds_read_b128 v[114:117], v74 offset:12288
    v_mfma_f32_16x16x32_bf16 a[60:63], v[178:181], a[196:199], a[60:63]
    buffer_load_dwordx4 v69, s[96:99], s56 offen offset:1024 lds
    v_mfma_f32_16x16x32_bf16 a[60:63], v[182:185], a[200:203], a[60:63]
    v_mfma_f32_16x16x32_bf16 a[60:63], v[186:189], a[204:207], a[60:63]
    s_waitcnt lgkmcnt(15)
    v_mfma_f32_16x16x32_bf16 a[0:3], v[118:121], a[64:67], a[0:3]
    s_lshl_b32 s68, s44, 11
    s_add_u32 s68, s68, 20480
    v_mfma_f32_16x16x32_bf16 a[0:3], v[122:125], a[68:71], a[0:3]
    ds_read_b128 a[136:139], v29 offset:512
    v_mfma_f32_16x16x32_bf16 a[0:3], v[126:129], a[72:75], a[0:3]
    s_waitcnt lgkmcnt(11)
    v_bfi_b32 v154, s55, v82, v86
    v_mfma_f32_16x16x32_bf16 a[0:3], v[130:133], a[88:91], a[0:3]
    ds_read_b128 a[140:143], v28 offset:512
    v_alignbit_b32 v158, v87, v82, 16
    v_mfma_f32_16x16x32_bf16 a[0:3], v[134:137], a[92:95], a[0:3]
    buffer_load_dwordx4 v70, s[96:99], s56 offen offset:2048 lds
    v_mfma_f32_16x16x32_bf16 a[0:3], v[138:141], a[96:99], a[0:3]
    s_waitcnt lgkmcnt(11)
    v_mfma_f32_16x16x32_bf16 a[0:3], v[142:145], a[112:115], a[0:3]
    v_add_u32 v52, s68, v31
    v_add_u32 v53, 81920, v52
    v_mfma_f32_16x16x32_bf16 a[0:3], v[146:149], a[116:119], a[0:3]
    v_bfi_b32 v162, s55, v83, v87
    ds_read_b128 a[144:147], v28 offset:528
    v_mfma_f32_16x16x32_bf16 a[0:3], v[150:153], a[120:123], a[0:3]
    v_mov_b32 v60, 0
    v_mov_b32 v61, 0
    v_mfma_f32_16x16x32_bf16 a[4:7], v[118:121], a[76:79], a[4:7]
    ds_read_b128 a[148:151], v28 offset:752
    v_alignbit_b32 v166, v88, v83, 16
    v_mfma_f32_16x16x32_bf16 a[4:7], v[122:125], a[80:83], a[4:7]
    v_bfi_b32 v170, s55, v84, v88
    v_mfma_f32_16x16x32_bf16 a[4:7], v[126:129], a[84:87], a[4:7]
    v_mov_b32 v62, 0
    v_mov_b32 v63, 0
    v_mfma_f32_16x16x32_bf16 a[4:7], v[130:133], a[100:103], a[4:7]
    ds_read_b128 a[152:155], v28 offset:768
    v_alignbit_b32 v174, v89, v84, 16
    v_mfma_f32_16x16x32_bf16 a[4:7], v[134:137], a[104:107], a[4:7]
    buffer_load_dwordx4 v71, s[96:99], s56 offen offset:3072 lds
    v_mfma_f32_16x16x32_bf16 a[4:7], v[138:141], a[108:111], a[4:7]
    ds_read_b128 a[156:159], v30 offset:784
    s_waitcnt lgkmcnt(10)
    v_mfma_f32_16x16x32_bf16 a[4:7], v[142:145], a[124:127], a[4:7]
    v_bfi_b32 v178, s55, v85, v89
    v_alignbit_b32 v182, v90, v85, 16
    v_mfma_f32_16x16x32_bf16 a[4:7], v[146:149], a[128:131], a[4:7]
    v_bfi_b32 v186, s55, v86, v90
    s_add_u32 m0, s53, 8192
    v_mfma_f32_16x16x32_bf16 a[4:7], v[150:153], a[132:135], a[4:7]
    buffer_load_dwordx4 v72, s[96:99], s56 offen offset:0 lds
    v_mfma_f32_16x16x32_bf16 a[8:11], v[118:121], a[88:91], a[8:11]
    v_bfi_b32 v155, s55, v91, v95
    v_alignbit_b32 v159, v96, v91, 16
    v_mfma_f32_16x16x32_bf16 a[8:11], v[122:125], a[92:95], a[8:11]
    v_bfi_b32 v163, s55, v92, v96
    v_alignbit_b32 v167, v97, v92, 16
    v_mfma_f32_16x16x32_bf16 a[8:11], v[126:129], a[96:99], a[8:11]
    buffer_load_dwordx4 v73, s[96:99], s56 offen offset:1024 lds
    v_mfma_f32_16x16x32_bf16 a[8:11], v[130:133], a[112:115], a[8:11]
    ds_write_b128 v51, a[0:3] offset:8192
    v_mfma_f32_16x16x32_bf16 a[8:11], v[134:137], a[116:119], a[8:11]
    v_bfi_b32 v171, s55, v93, v97
    v_alignbit_b32 v175, v98, v93, 16
    v_mfma_f32_16x16x32_bf16 a[8:11], v[138:141], a[120:123], a[8:11]
    v_bfi_b32 v179, s55, v94, v98
    s_waitcnt lgkmcnt(4)
    v_mfma_f32_16x16x32_bf16 a[8:11], v[142:145], a[136:139], a[8:11]
    s_add_u32 m0, s53, 10240
    v_alignbit_b32 v183, v99, v94, 16
    v_mfma_f32_16x16x32_bf16 a[8:11], v[146:149], a[140:143], a[8:11]
    buffer_load_dwordx4 v64, s[96:99], s57 offen offset:0 lds
    v_mfma_f32_16x16x32_bf16 a[8:11], v[150:153], a[144:147], a[8:11]
    s_waitcnt vmcnt(11)
    ds_read_b128 a[160:163], v29 offset:4096
    v_mfma_f32_16x16x32_bf16 a[12:15], v[118:121], a[100:103], a[12:15]
    v_bfi_b32 v187, s55, v95, v99
    ds_read_b128 a[164:167], v28 offset:4096
    v_mfma_f32_16x16x32_bf16 a[12:15], v[122:125], a[104:107], a[12:15]
    v_bfi_b32 v156, s55, v100, v104
    ds_read_b128 a[168:171], v28 offset:4112
    v_mfma_f32_16x16x32_bf16 a[12:15], v[126:129], a[108:111], a[12:15]
    v_alignbit_b32 v160, v105, v100, 16
    v_mfma_f32_16x16x32_bf16 a[12:15], v[130:133], a[124:127], a[12:15]
    ds_write_b128 v51, a[4:7] offset:9216
    v_mfma_f32_16x16x32_bf16 a[12:15], v[134:137], a[128:131], a[12:15]
    ds_read_b128 a[172:175], v28 offset:4336
    v_bfi_b32 v164, s55, v101, v105
    v_mfma_f32_16x16x32_bf16 a[12:15], v[138:141], a[132:135], a[12:15]
    s_waitcnt lgkmcnt(6)
    v_mfma_f32_16x16x32_bf16 a[12:15], v[142:145], a[148:151], a[12:15]
    buffer_load_dwordx4 v65, s[96:99], s57 offen offset:1024 lds
    v_mfma_f32_16x16x32_bf16 a[12:15], v[146:149], a[152:155], a[12:15]
    ds_read_b128 a[176:179], v28 offset:4352
    v_alignbit_b32 v168, v106, v101, 16
    v_mfma_f32_16x16x32_bf16 a[12:15], v[150:153], a[156:159], a[12:15]
    ds_read_b128 a[180:183], v30 offset:4368
    v_bfi_b32 v172, s55, v102, v106
    v_mfma_f32_16x16x32_bf16 a[16:19], v[118:121], a[112:115], a[16:19]
    v_alignbit_b32 v176, v107, v102, 16
    v_mfma_f32_16x16x32_bf16 a[16:19], v[122:125], a[116:119], a[16:19]
    buffer_load_dwordx4 v66, s[96:99], s57 offen offset:2048 lds
    v_mfma_f32_16x16x32_bf16 a[16:19], v[126:129], a[120:123], a[16:19]
    v_bfi_b32 v180, s55, v103, v107
    v_alignbit_b32 v184, v108, v103, 16
    v_mfma_f32_16x16x32_bf16 a[16:19], v[130:133], a[136:139], a[16:19]
    v_bfi_b32 v188, s55, v104, v108
    v_mfma_f32_16x16x32_bf16 a[16:19], v[134:137], a[140:143], a[16:19]
    ds_write_b128 v51, a[8:11] offset:10240
    v_mfma_f32_16x16x32_bf16 a[16:19], v[138:141], a[144:147], a[16:19]
    v_bfi_b32 v157, s55, v109, v113
    s_waitcnt lgkmcnt(5)
    v_mfma_f32_16x16x32_bf16 a[16:19], v[142:145], a[160:163], a[16:19]
    buffer_load_dwordx4 v67, s[96:99], s57 offen offset:3072 lds
    v_mfma_f32_16x16x32_bf16 a[16:19], v[146:149], a[164:167], a[16:19]
    v_alignbit_b32 v161, v114, v109, 16
    v_bfi_b32 v165, s55, v110, v114
    v_mfma_f32_16x16x32_bf16 a[16:19], v[150:153], a[168:171], a[16:19]
    ds_read_b128 a[184:187], v29 offset:4608
    v_alignbit_b32 v169, v115, v110, 16
    v_mfma_f32_16x16x32_bf16 a[20:23], v[118:121], a[124:127], a[20:23]
    s_add_u32 m0, s53, 14336
    ds_read_b128 a[188:191], v28 offset:4608
    v_mfma_f32_16x16x32_bf16 a[20:23], v[122:125], a[128:131], a[20:23]
    v_bfi_b32 v173, s55, v111, v115
    v_mfma_f32_16x16x32_bf16 a[20:23], v[126:129], a[132:135], a[20:23]
    buffer_load_dwordx4 v68, s[96:99], s57 offen offset:0 lds
    v_mfma_f32_16x16x32_bf16 a[20:23], v[130:133], a[148:151], a[20:23]
    v_alignbit_b32 v177, v116, v111, 16
    ds_read_b128 a[192:195], v28 offset:4624
    v_mfma_f32_16x16x32_bf16 a[20:23], v[134:137], a[152:155], a[20:23]
    ds_write_b128 v51, a[12:15] offset:11264
    v_mfma_f32_16x16x32_bf16 a[20:23], v[138:141], a[156:159], a[20:23]
    ds_read_b128 a[196:199], v28 offset:4848
    s_waitcnt lgkmcnt(6)
    v_mfma_f32_16x16x32_bf16 a[20:23], v[142:145], a[172:175], a[20:23]
    v_bfi_b32 v181, s55, v112, v116
    v_alignbit_b32 v185, v117, v112, 16
    v_mfma_f32_16x16x32_bf16 a[20:23], v[146:149], a[176:179], a[20:23]
    ds_read_b128 a[200:203], v28 offset:4864
    v_bfi_b32 v189, s55, v113, v117
    v_mfma_f32_16x16x32_bf16 a[20:23], v[150:153], a[180:183], a[20:23]
    buffer_load_dwordx4 v69, s[96:99], s57 offen offset:1024 lds
    v_mfma_f32_16x16x32_bf16 a[24:27], v[118:121], a[136:139], a[24:27]
    ds_read_b128 a[204:207], v30 offset:4880
    v_mfma_f32_16x16x32_bf16 a[24:27], v[122:125], a[140:143], a[24:27]
    s_waitcnt vmcnt(6)
    ds_read_b128 v[82:85], v74 offset:0
    v_mfma_f32_16x16x32_bf16 a[24:27], v[126:129], a[144:147], a[24:27]
    buffer_load_dwordx4 v70, s[96:99], s57 offen offset:2048 lds
    v_mfma_f32_16x16x32_bf16 a[24:27], v[130:133], a[160:163], a[24:27]
    ds_write_b128 v51, a[16:19] offset:12288
    v_mfma_f32_16x16x32_bf16 a[24:27], v[134:137], a[164:167], a[24:27]
    ds_read_b128 v[86:89], v75 offset:0
    ds_read_b128 v[90:93], v76 offset:0
    v_mfma_f32_16x16x32_bf16 a[24:27], v[138:141], a[168:171], a[24:27]
    s_waitcnt lgkmcnt(8)
    v_mfma_f32_16x16x32_bf16 a[24:27], v[142:145], a[184:187], a[24:27]
    buffer_load_dwordx4 v71, s[96:99], s57 offen offset:3072 lds
    v_mfma_f32_16x16x32_bf16 a[24:27], v[146:149], a[188:191], a[24:27]
    ds_read_b128 v[94:97], v77 offset:0
    ds_read_b128 v[98:101], v74 offset:1024
    v_mfma_f32_16x16x32_bf16 a[24:27], v[150:153], a[192:195], a[24:27]
    s_add_u32 m0, s53, 18432
    ds_read_b128 v[102:105], v75 offset:1024
    v_mfma_f32_16x16x32_bf16 a[28:31], v[118:121], a[148:151], a[28:31]
    buffer_load_dwordx4 v72, s[96:99], s57 offen offset:0 lds
    v_mfma_f32_16x16x32_bf16 a[28:31], v[122:125], a[152:155], a[28:31]
    ds_write_b128 v51, a[20:23] offset:13312
    v_mfma_f32_16x16x32_bf16 a[28:31], v[126:129], a[156:159], a[28:31]
    ds_read_b128 v[106:109], v76 offset:1024
    v_mfma_f32_16x16x32_bf16 a[28:31], v[130:133], a[172:175], a[28:31]
    ds_read_b128 v[110:113], v77 offset:1024
    v_mfma_f32_16x16x32_bf16 a[28:31], v[134:137], a[176:179], a[28:31]
    buffer_load_dwordx4 v73, s[96:99], s57 offen offset:1024 lds
    v_mfma_f32_16x16x32_bf16 a[28:31], v[138:141], a[180:183], a[28:31]
    ds_read_b128 v[114:117], v74 offset:2048
    s_waitcnt lgkmcnt(11)
    v_mfma_f32_16x16x32_bf16 a[28:31], v[142:145], a[196:199], a[28:31]
    v_mfma_f32_16x16x32_bf16 a[28:31], v[146:149], a[200:203], a[28:31]
    v_mfma_f32_16x16x32_bf16 a[28:31], v[150:153], a[204:207], a[28:31]
    ds_write_b128 v51, a[24:27] offset:14336
    v_mfma_f32_16x16x32_bf16 a[32:35], v[154:157], a[64:67], a[32:35]
    v_mfma_f32_16x16x32_bf16 a[32:35], v[158:161], a[68:71], a[32:35]
    s_waitcnt lgkmcnt(1)
    s_add_u32 m0, s53, 0
    v_mfma_f32_16x16x32_bf16 a[32:35], v[162:165], a[72:75], a[32:35]
    buffer_load_dwordx4 v65, s[96:99], s58 offen offset:1024 lds
    v_mfma_f32_16x16x32_bf16 a[32:35], v[166:169], a[88:91], a[32:35]
    v_mfma_f32_16x16x32_bf16 a[32:35], v[170:173], a[92:95], a[32:35]
    v_mfma_f32_16x16x32_bf16 a[32:35], v[174:177], a[96:99], a[32:35]
    v_mfma_f32_16x16x32_bf16 a[32:35], v[178:181], a[112:115], a[32:35]
    v_mfma_f32_16x16x32_bf16 a[32:35], v[182:185], a[116:119], a[32:35]
    buffer_load_dwordx4 v66, s[96:99], s58 offen offset:2048 lds
    v_mfma_f32_16x16x32_bf16 a[32:35], v[186:189], a[120:123], a[32:35]
    ds_write_b128 v51, a[28:31] offset:15360
    v_mfma_f32_16x16x32_bf16 a[36:39], v[154:157], a[76:79], a[36:39]
    v_mfma_f32_16x16x32_bf16 a[36:39], v[158:161], a[80:83], a[36:39]
    v_mfma_f32_16x16x32_bf16 a[36:39], v[162:165], a[84:87], a[36:39]
    v_mfma_f32_16x16x32_bf16 a[36:39], v[166:169], a[100:103], a[36:39]
    buffer_load_dwordx4 v67, s[96:99], s58 offen offset:3072 lds
    v_mfma_f32_16x16x32_bf16 a[36:39], v[170:173], a[104:107], a[36:39]
    v_mfma_f32_16x16x32_bf16 a[36:39], v[174:177], a[108:111], a[36:39]
    s_waitcnt lgkmcnt(0)
    s_barrier
    v_mfma_f32_16x16x32_bf16 a[36:39], v[178:181], a[124:127], a[36:39]
    ds_read_b128 v[216:219], v52 offset:8192
    v_mfma_f32_16x16x32_bf16 a[36:39], v[182:185], a[128:131], a[36:39]
    s_add_u32 m0, s53, 4096
    ds_read_b128 v[232:235], v52 offset:49152
    v_mfma_f32_16x16x32_bf16 a[36:39], v[186:189], a[132:135], a[36:39]
    buffer_load_dwordx4 v68, s[96:99], s58 offen offset:0 lds
    v_mfma_f32_16x16x32_bf16 a[40:43], v[154:157], a[88:91], a[40:43]
    ds_write_b128 v51, a[32:35] offset:0
    v_mfma_f32_16x16x32_bf16 a[40:43], v[158:161], a[92:95], a[40:43]
    ds_read_b128 v[236:239], v53 offset:8192
    ds_read_b128 v[240:243], v53 offset:49152
    v_mfma_f32_16x16x32_bf16 a[40:43], v[162:165], a[96:99], a[40:43]
    ds_read_b128 v[220:223], v52 offset:9216
    ds_read_b128 v[244:247], v52 offset:50176
    v_mfma_f32_16x16x32_bf16 a[40:43], v[166:169], a[112:115], a[40:43]
    ds_read_b128 v[248:251], v53 offset:9216
    v_mfma_f32_16x16x32_bf16 a[40:43], v[170:173], a[116:119], a[40:43]
    buffer_load_dwordx4 v69, s[96:99], s58 offen offset:1024 lds
    v_mfma_f32_16x16x32_bf16 a[40:43], v[174:177], a[120:123], a[40:43]
    ds_read_b128 v[252:255], v53 offset:50176
    v_mfma_f32_16x16x32_bf16 a[40:43], v[178:181], a[136:139], a[40:43]
    v_mfma_f32_16x16x32_bf16 a[40:43], v[182:185], a[140:143], a[40:43]
    v_mfma_f32_16x16x32_bf16 a[40:43], v[186:189], a[144:147], a[40:43]
    ds_write_b128 v51, a[36:39] offset:1024
    v_mfma_f32_16x16x32_bf16 a[44:47], v[154:157], a[100:103], a[44:47]
    s_waitcnt lgkmcnt(5)
    v_add_f32 v216, v216, v232
    v_mfma_f32_16x16x32_bf16 a[44:47], v[158:161], a[104:107], a[44:47]
    v_add_f32 v217, v217, v233
    v_mfma_f32_16x16x32_bf16 a[44:47], v[162:165], a[108:111], a[44:47]
    buffer_load_dwordx4 v70, s[96:99], s58 offen offset:2048 lds
    v_mfma_f32_16x16x32_bf16 a[44:47], v[166:169], a[124:127], a[44:47]
    v_add_f32 v218, v218, v234
    v_add_f32 v219, v219, v235
    v_mfma_f32_16x16x32_bf16 a[44:47], v[170:173], a[128:131], a[44:47]
    v_add_f32 v216, v216, v236
    v_add_f32 v217, v217, v237
    v_mfma_f32_16x16x32_bf16 a[44:47], v[174:177], a[132:135], a[44:47]
    v_add_f32 v218, v218, v238
    v_mfma_f32_16x16x32_bf16 a[44:47], v[178:181], a[148:151], a[44:47]
    buffer_load_dwordx4 v71, s[96:99], s58 offen offset:3072 lds
    v_mfma_f32_16x16x32_bf16 a[44:47], v[182:185], a[152:155], a[44:47]
    v_add_f32 v219, v219, v239
    v_add_f32 v216, v216, v240
    v_mfma_f32_16x16x32_bf16 a[44:47], v[186:189], a[156:159], a[44:47]
    v_add_f32 v217, v217, v241
    v_add_f32 v218, v218, v242
    v_mfma_f32_16x16x32_bf16 a[48:51], v[154:157], a[112:115], a[48:51]
    ds_write_b128 v51, a[40:43] offset:2048
    v_mfma_f32_16x16x32_bf16 a[48:51], v[158:161], a[116:119], a[48:51]
    v_add_f32 v219, v219, v243
    s_add_u32 m0, s53, 8192
    v_mfma_f32_16x16x32_bf16 a[48:51], v[162:165], a[120:123], a[48:51]
    v_add_f32 v216, v216, v32
    v_mfma_f32_16x16x32_bf16 a[48:51], v[166:169], a[136:139], a[48:51]
    buffer_load_dwordx4 v72, s[96:99], s58 offen offset:0 lds
    v_mfma_f32_16x16x32_bf16 a[48:51], v[170:173], a[140:143], a[48:51]
    v_add_f32 v217, v217, v33
    v_add_f32 v218, v218, v34
    v_mfma_f32_16x16x32_bf16 a[48:51], v[174:177], a[144:147], a[48:51]
    v_add_f32 v219, v219, v35
    v_fmac_f32 v62, v216, v216
    v_mfma_f32_16x16x32_bf16 a[48:51], v[178:181], a[160:163], a[48:51]
    v_add_f32 v60, v60, v216
    v_fmac_f32 v63, v217, v217
    v_mfma_f32_16x16x32_bf16 a[48:51], v[182:185], a[164:167], a[48:51]
    v_add_f32 v61, v61, v217
    v_fmac_f32 v62, v218, v218
    v_mfma_f32_16x16x32_bf16 a[48:51], v[186:189], a[168:171], a[48:51]
    ds_write_b128 v51, a[44:47] offset:3072
    v_mfma_f32_16x16x32_bf16 a[52:55], v[154:157], a[124:127], a[52:55]
    v_add_f32 v60, v60, v218
    v_fmac_f32 v63, v219, v219
    v_mfma_f32_16x16x32_bf16 a[52:55], v[158:161], a[128:131], a[52:55]
    v_add_f32 v61, v61, v219
    v_mfma_f32_16x16x32_bf16 a[52:55], v[162:165], a[132:135], a[52:55]
    s_waitcnt lgkmcnt(3)
    v_add_f32 v220, v220, v244
    v_mfma_f32_16x16x32_bf16 a[52:55], v[166:169], a[148:151], a[52:55]
    v_add_f32 v221, v221, v245
    v_add_f32 v222, v222, v246
    v_mfma_f32_16x16x32_bf16 a[52:55], v[170:173], a[152:155], a[52:55]
    v_add_f32 v223, v223, v247
    v_mfma_f32_16x16x32_bf16 a[52:55], v[174:177], a[156:159], a[52:55]
    v_add_f32 v220, v220, v248
    v_mfma_f32_16x16x32_bf16 a[52:55], v[178:181], a[172:175], a[52:55]
    v_add_f32 v221, v221, v249
    v_mfma_f32_16x16x32_bf16 a[52:55], v[182:185], a[176:179], a[52:55]
    v_add_f32 v222, v222, v250
    v_mfma_f32_16x16x32_bf16 a[52:55], v[186:189], a[180:183], a[52:55]
    ds_write_b128 v51, a[48:51] offset:4096
    v_mfma_f32_16x16x32_bf16 a[56:59], v[154:157], a[136:139], a[56:59]
    v_add_f32 v223, v223, v251
    v_add_f32 v220, v220, v252
    v_mfma_f32_16x16x32_bf16 a[56:59], v[158:161], a[140:143], a[56:59]
    v_add_f32 v221, v221, v253
    v_add_f32 v222, v222, v254
    v_mfma_f32_16x16x32_bf16 a[56:59], v[162:165], a[144:147], a[56:59]
    v_add_f32 v223, v223, v255
    v_mfma_f32_16x16x32_bf16 a[56:59], v[166:169], a[160:163], a[56:59]
    v_add_f32 v220, v220, v32
    v_mfma_f32_16x16x32_bf16 a[56:59], v[170:173], a[164:167], a[56:59]
    v_add_f32 v221, v221, v33
    v_mfma_f32_16x16x32_bf16 a[56:59], v[174:177], a[168:171], a[56:59]
    v_add_f32 v222, v222, v34
    v_mfma_f32_16x16x32_bf16 a[56:59], v[178:181], a[184:187], a[56:59]
    v_add_f32 v223, v223, v35
    v_mfma_f32_16x16x32_bf16 a[56:59], v[182:185], a[188:191], a[56:59]
    v_fmac_f32 v62, v220, v220
    v_add_f32 v60, v60, v220
    v_mfma_f32_16x16x32_bf16 a[56:59], v[186:189], a[192:195], a[56:59]
    ds_write_b128 v51, a[52:55] offset:5120
    v_mfma_f32_16x16x32_bf16 a[60:63], v[154:157], a[148:151], a[60:63]
    v_fmac_f32 v63, v221, v221
    v_add_f32 v61, v61, v221
    v_mfma_f32_16x16x32_bf16 a[60:63], v[158:161], a[152:155], a[60:63]
    v_fmac_f32 v62, v222, v222
    v_mfma_f32_16x16x32_bf16 a[60:63], v[162:165], a[156:159], a[60:63]
    v_add_f32 v60, v60, v222
    v_mfma_f32_16x16x32_bf16 a[60:63], v[166:169], a[172:175], a[60:63]
    v_fmac_f32 v63, v223, v223
    v_mfma_f32_16x16x32_bf16 a[60:63], v[170:173], a[176:179], a[60:63]
    v_add_f32 v61, v61, v223
    v_mfma_f32_16x16x32_bf16 a[60:63], v[174:177], a[180:183], a[60:63]
    v_mfma_f32_16x16x32_bf16 a[60:63], v[178:181], a[196:199], a[60:63]
    v_mfma_f32_16x16x32_bf16 a[60:63], v[182:185], a[200:203], a[60:63]
    v_mfma_f32_16x16x32_bf16 a[60:63], v[186:189], a[204:207], a[60:63]
    ds_write_b128 v51, a[56:59] offset:6144
    s_nop 7
    ds_write_b128 v51, a[60:63] offset:7168
    s_waitcnt lgkmcnt(0)
    s_barrier
    ds_read_b128 v[224:227], v52 offset:0
    ds_read_b128 v[232:235], v52 offset:40960
    ds_read_b128 v[236:239], v53 offset:0
    ds_read_b128 v[240:243], v53 offset:40960
    ds_read_b128 v[228:231], v52 offset:1024
    ds_read_b128 v[244:247], v52 offset:41984
    ds_read_b128 v[248:251], v53 offset:1024
    ds_read_b128 v[252:255], v53 offset:41984
    s_waitcnt lgkmcnt(4)
    v_pk_add_f32 v[224:225], v[224:225], v[232:233]
    v_pk_add_f32 v[226:227], v[226:227], v[234:235]
    v_pk_add_f32 v[224:225], v[224:225], v[236:237]
    v_pk_add_f32 v[226:227], v[226:227], v[238:239]
    v_pk_add_f32 v[224:225], v[224:225], v[240:241]
    v_pk_add_f32 v[226:227], v[226:227], v[242:243]
    v_pk_add_f32 v[224:225], v[224:225], v[36:37]
    v_pk_add_f32 v[226:227], v[226:227], v[38:39]
    v_pk_fma_f32 v[62:63], v[224:225], v[224:225], v[62:63]
    v_pk_add_f32 v[60:61], v[60:61], v[224:225]
    v_pk_fma_f32 v[62:63], v[226:227], v[226:227], v[62:63]
    v_pk_add_f32 v[60:61], v[60:61], v[226:227]
    s_waitcnt lgkmcnt(0)
    v_pk_add_f32 v[228:229], v[228:229], v[244:245]
    v_pk_add_f32 v[230:231], v[230:231], v[246:247]
    v_pk_add_f32 v[228:229], v[228:229], v[248:249]
    v_pk_add_f32 v[230:231], v[230:231], v[250:251]
    v_pk_add_f32 v[228:229], v[228:229], v[252:253]
    v_pk_add_f32 v[230:231], v[230:231], v[254:255]
    v_pk_add_f32 v[228:229], v[228:229], v[36:37]
    v_pk_add_f32 v[230:231], v[230:231], v[38:39]
    v_pk_fma_f32 v[62:63], v[228:229], v[228:229], v[62:63]
    v_pk_add_f32 v[60:61], v[60:61], v[228:229]
    v_pk_fma_f32 v[62:63], v[230:231], v[230:231], v[62:63]
    v_pk_add_f32 v[60:61], v[60:61], v[230:231]
    v_add_f32 v60, v60, v61
    v_add_f32 v61, v62, v63
    s_nop 0
    s_nop 0
    v_add_f32_dpp v60, v60, v60 quad_perm:[1,0,3,2] row_mask:0xf bank_mask:0xf
    v_add_f32_dpp v61, v61, v61 quad_perm:[1,0,3,2] row_mask:0xf bank_mask:0xf
    s_nop 0
    v_add_f32_dpp v60, v60, v60 quad_perm:[2,3,0,1] row_mask:0xf bank_mask:0xf
    v_add_f32_dpp v61, v61, v61 quad_perm:[2,3,0,1] row_mask:0xf bank_mask:0xf
    s_nop 0
    v_add_f32_dpp v60, v60, v60 row_half_mirror row_mask:0xf bank_mask:0xf
    v_add_f32_dpp v61, v61, v61 row_half_mirror row_mask:0xf bank_mask:0xf
    s_nop 0
    v_add_f32_dpp v60, v60, v60 row_mirror row_mask:0xf bank_mask:0xf
    v_add_f32_dpp v61, v61, v61 row_mirror row_mask:0xf bank_mask:0xf
    s_nop 0
    v_add_f32_dpp v60, v60, v60 row_bcast:15 row_mask:0xa bank_mask:0xf
    v_add_f32_dpp v61, v61, v61 row_bcast:15 row_mask:0xa bank_mask:0xf
    s_nop 0
    v_add_f32_dpp v60, v60, v60 row_bcast:31 row_mask:0xc bank_mask:0xf
    v_add_f32_dpp v61, v61, v61 row_bcast:31 row_mask:0xc bank_mask:0xf
    v_readlane_b32 s86, v60, 63
    s_nop 0
    v_readlane_b32 s87, v61, 63
    v_mov_b32 v57, s54
    v_mov_b32 v59, s54
    v_mov_b32 v56, s86
    v_mov_b32 v58, s87
    s_lshl_b32 s74, s84, 2
    s_add_u32 s74, s74, s44
    s_lshl_b32 s70, s74, 4
    s_add_u32 s70, s70, 7487488
    s_lshl_b32 s71, s74, 7
    s_add_u32 s71, s71, 7733248
    v_mov_b32 v61, 0
    v_cmp_eq_u32 vcc, 0, v2
    s_and_saveexec_b64 s[90:91], vcc
    buffer_store_dwordx4 v[56:59], v61, s[28:31], s70 offen
    s_mov_b64 exec, s[90:91]
    v_and_b32 v60, 63, v2
    v_lshlrev_b32 v60, 4, v60
    s_lshl_b32 s68, s45, 11
    s_add_u32 s68, s68, 7487488
    s_mov_b32 s69, 0
    s_movk_i32 s72, 1024
L_p3:
    buffer_load_dwordx4 v[232:235], v60, s[28:31], s68 offen sc1
    s_add_u32 s73, s68, s72
    buffer_load_dwordx4 v[236:239], v60, s[28:31], s73 offen sc1
    s_waitcnt vmcnt(0)
    v_xor_b32 v61, s54, v233
    v_xor_b32 v62, s54, v235
    v_xor_b32 v63, s54, v237
    v_or3_b32 v61, v61, v62, v63
    v_xor_b32 v62, s54, v239
    v_or_b32 v61, v61, v62
    v_cmp_eq_u32 vcc, 0, v61
    s_add_u32 s69, s69, 1
    s_cmp_eq_u64 vcc, exec
    s_cbranch_scc1 L_p3_ok
    s_cmp_lg_u32 s69, 2
    s_cbranch_scc1 L_p3_c1
    v_mov_b32 v61, 0
    v_cmp_eq_u32 vcc, 0, v2
    s_and_saveexec_b64 s[90:91], vcc
    buffer_store_dwordx4 v[56:59], v61, s[28:31], s71 offen sc1
    s_mov_b64 exec, s[90:91]
L_p3_c1:
    s_cmp_lg_u32 s69, 12
    s_cbranch_scc1 L_p3_c2
    v_lshlrev_b32 v60, 3, v60
    s_movk_i32 s72, 8192
    s_lshl_b32 s68, s45, 14
    s_add_u32 s68, s68, 7733248
L_p3_c2:
    s_cmp_lt_u32 s69, 0x40000
    s_cbranch_scc1 L_p3
L_p3_ok:
    s_cmp_gt_u32 s69, 2
    s_cbranch_scc1 L_p3_c3
    v_mov_b32 v61, 0
    v_cmp_eq_u32 vcc, 0, v2
    s_and_saveexec_b64 s[90:91], vcc
    buffer_store_dwordx4 v[56:59], v61, s[28:31], s71 offen sc1
    s_mov_b64 exec, s[90:91]
L_p3_c3:
    v_add_f32 v232, v232, v236
    v_add_f32 v234, v234, v238
    s_nop 0
    s_nop 0
    v_add_f32_dpp v232, v232, v232 quad_perm:[1,0,3,2] row_mask:0xf bank_mask:0xf
    v_add_f32_dpp v234, v234, v234 quad_perm:[1,0,3,2] row_mask:0xf bank_mask:0xf
    s_nop 0
    v_add_f32_dpp v232, v232, v232 quad_perm:[2,3,0,1] row_mask:0xf bank_mask:0xf
    v_add_f32_dpp v234, v234, v234 quad_perm:[2,3,0,1] row_mask:0xf bank_mask:0xf
    s_nop 0
    v_add_f32_dpp v232, v232, v232 row_half_mirror row_mask:0xf bank_mask:0xf
    v_add_f32_dpp v234, v234, v234 row_half_mirror row_mask:0xf bank_mask:0xf
    s_nop 0
    v_add_f32_dpp v232, v232, v232 row_mirror row_mask:0xf bank_mask:0xf
    v_add_f32_dpp v234, v234, v234 row_mirror row_mask:0xf bank_mask:0xf
    s_nop 0
    v_add_f32_dpp v232, v232, v232 row_bcast:15 row_mask:0xa bank_mask:0xf
    v_add_f32_dpp v234, v234, v234 row_bcast:15 row_mask:0xa bank_mask:0xf
    s_nop 0
    v_add_f32_dpp v232, v232, v232 row_bcast:31 row_mask:0xc bank_mask:0xf
    v_add_f32_dpp v234, v234, v234 row_bcast:31 row_mask:0xc bank_mask:0xf
    v_readlane_b32 s86, v232, 63
    s_nop 0
    v_readlane_b32 s87, v234, 63
    v_mov_b32 v60, 0x37000000
    s_nop 0
    v_mul_f32 v62, s87, v60
    v_mul_f32 v60, s86, v60
    v_fma_f32 v62, -v60, v60, v62
    v_max_f32 v62, 0, v62
    v_add_f32 v62, 0x3727c5ac, v62
    v_rsq_f32 v62, v62
    v_sub_f32 v60, 0, v60
    v_mov_b32 v61, v60
    v_mov_b32 v63, v62
    v_pk_mul_f32 v[194:195], v[194:195], v[62:63]
    v_pk_fma_f32 v[202:203], v[194:195], v[60:61], v[202:203]
    v_pk_mul_f32 v[196:197], v[196:197], v[62:63]
    v_pk_fma_f32 v[204:205], v[196:197], v[60:61], v[204:205]
    v_pk_mul_f32 v[198:199], v[198:199], v[62:63]
    v_pk_fma_f32 v[206:207], v[198:199], v[60:61], v[206:207]
    v_pk_mul_f32 v[200:201], v[200:201], v[62:63]
    v_pk_fma_f32 v[208:209], v[200:201], v[60:61], v[208:209]
    v_pk_fma_f32 v[216:217], v[216:217], v[194:195], v[202:203]
    v_pk_fma_f32 v[218:219], v[218:219], v[196:197], v[204:205]
    v_pk_fma_f32 v[220:221], v[220:221], v[194:195], v[202:203]
    v_pk_fma_f32 v[222:223], v[222:223], v[196:197], v[204:205]
    v_pk_mul_f32 v[232:233], v[216:217], s[80:81]
    v_pk_mul_f32 v[234:235], v[218:219], s[80:81]
    v_pk_mul_f32 v[236:237], v[220:221], s[80:81]
    v_pk_mul_f32 v[238:239], v[222:223], s[80:81]
    v_exp_f32 v232, v232
    v_exp_f32 v233, v233
    v_exp_f32 v234, v234
    v_exp_f32 v235, v235
    v_exp_f32 v236, v236
    v_exp_f32 v237, v237
    v_exp_f32 v238, v238
    v_exp_f32 v239, v239
    v_pk_add_f32 v[232:233], v[232:233], s[82:83]
    v_pk_add_f32 v[234:235], v[234:235], s[82:83]
    v_pk_add_f32 v[236:237], v[236:237], s[82:83]
    v_pk_add_f32 v[238:239], v[238:239], s[82:83]
    v_rcp_f32 v232, v232
    v_rcp_f32 v233, v233
    v_rcp_f32 v234, v234
    v_rcp_f32 v235, v235
    v_rcp_f32 v236, v236
    v_rcp_f32 v237, v237
    v_rcp_f32 v238, v238
    v_rcp_f32 v239, v239
    v_pk_mul_f32 v[216:217], v[216:217], v[232:233]
    v_pk_mul_f32 v[218:219], v[218:219], v[234:235]
    v_pk_mul_f32 v[220:221], v[220:221], v[236:237]
    v_pk_mul_f32 v[222:223], v[222:223], v[238:239]
    v_cvt_pk_bf16_f32 v240, v216, v217
    v_cvt_pk_bf16_f32 v241, v218, v219
    v_cvt_pk_bf16_f32 v242, v220, v221
    v_cvt_pk_bf16_f32 v243, v222, v223
    s_nop 1
    v_permlane16_swap_b32 v240, v242
    v_permlane16_swap_b32 v241, v243
    buffer_store_dwordx4 v[240:243], v48, s[28:31], s88 offen sc1
    v_pk_fma_f32 v[224:225], v[224:225], v[198:199], v[206:207]
    v_pk_fma_f32 v[226:227], v[226:227], v[200:201], v[208:209]
    v_pk_fma_f32 v[228:229], v[228:229], v[198:199], v[206:207]
    v_pk_fma_f32 v[230:231], v[230:231], v[200:201], v[208:209]
    v_pk_mul_f32 v[232:233], v[224:225], s[80:81]
    v_pk_mul_f32 v[234:235], v[226:227], s[80:81]
    v_pk_mul_f32 v[236:237], v[228:229], s[80:81]
    v_pk_mul_f32 v[238:239], v[230:231], s[80:81]
    v_exp_f32 v232, v232
    v_exp_f32 v233, v233
    v_exp_f32 v234, v234
    v_exp_f32 v235, v235
    v_exp_f32 v236, v236
    v_exp_f32 v237, v237
    v_exp_f32 v238, v238
    v_exp_f32 v239, v239
    v_pk_add_f32 v[232:233], v[232:233], s[82:83]
    v_pk_add_f32 v[234:235], v[234:235], s[82:83]
    v_pk_add_f32 v[236:237], v[236:237], s[82:83]
    v_pk_add_f32 v[238:239], v[238:239], s[82:83]
    v_rcp_f32 v232, v232
    v_rcp_f32 v233, v233
    v_rcp_f32 v234, v234
    v_rcp_f32 v235, v235
    v_rcp_f32 v236, v236
    v_rcp_f32 v237, v237
    v_rcp_f32 v238, v238
    v_rcp_f32 v239, v239
    v_pk_mul_f32 v[224:225], v[224:225], v[232:233]
    v_pk_mul_f32 v[226:227], v[226:227], v[234:235]
    v_pk_mul_f32 v[228:229], v[228:229], v[236:237]
    v_pk_mul_f32 v[230:231], v[230:231], v[238:239]
    v_cvt_pk_bf16_f32 v244, v224, v225
    v_cvt_pk_bf16_f32 v245, v226, v227
    v_cvt_pk_bf16_f32 v246, v228, v229
    v_cvt_pk_bf16_f32 v247, v230, v231
    s_nop 1
    v_permlane16_swap_b32 v244, v246
    v_permlane16_swap_b32 v245, v247
    buffer_store_dwordx4 v[244:247], v48, s[28:31], s89 offen sc1
    v_bfi_b32 v118, s55, v82, v86
    v_alignbit_b32 v122, v87, v82, 16
    v_bfi_b32 v126, s55, v83, v87
    v_alignbit_b32 v130, v88, v83, 16
    v_bfi_b32 v134, s55, v84, v88
    v_alignbit_b32 v138, v89, v84, 16
    v_bfi_b32 v142, s55, v85, v89
    v_alignbit_b32 v146, v90, v85, 16
    v_bfi_b32 v150, s55, v86, v90
    v_bfi_b32 v119, s55, v91, v95
    v_alignbit_b32 v123, v96, v91, 16
    v_bfi_b32 v127, s55, v92, v96
    v_alignbit_b32 v131, v97, v92, 16
    v_bfi_b32 v135, s55, v93, v97
    v_alignbit_b32 v139, v98, v93, 16
    v_bfi_b32 v143, s55, v94, v98
    v_alignbit_b32 v147, v99, v94, 16
    v_bfi_b32 v151, s55, v95, v99
    v_bfi_b32 v120, s55, v100, v104
    v_alignbit_b32 v124, v105, v100, 16
    v_bfi_b32 v128, s55, v101, v105
    v_alignbit_b32 v132, v106, v101, 16
    v_bfi_b32 v136, s55, v102, v106
    v_alignbit_b32 v140, v107, v102, 16
    v_bfi_b32 v144, s55, v103, v107
    v_alignbit_b32 v148, v108, v103, 16
    v_bfi_b32 v152, s55, v104, v108
    v_bfi_b32 v121, s55, v109, v113
    v_alignbit_b32 v125, v114, v109, 16
    v_bfi_b32 v129, s55, v110, v114
    v_alignbit_b32 v133, v115, v110, 16
    v_bfi_b32 v137, s55, v111, v115
    v_alignbit_b32 v141, v116, v111, 16
    v_bfi_b32 v145, s55, v112, v116
    v_alignbit_b32 v149, v117, v112, 16
    v_bfi_b32 v153, s55, v113, v117
    ds_read_b128 v[82:85], v74 offset:10240
    ds_read_b128 v[86:89], v75 offset:10240
    ds_read_b128 v[90:93], v76 offset:10240
    ds_read_b128 v[94:97], v77 offset:10240
    ds_read_b128 v[98:101], v74 offset:11264
    ds_read_b128 v[102:105], v75 offset:11264
    ds_read_b128 v[106:109], v76 offset:11264
    ds_read_b128 v[110:113], v77 offset:11264
    ds_read_b128 v[114:117], v74 offset:12288
    s_waitcnt lgkmcnt(6)
    v_bfi_b32 v154, s55, v82, v86
    v_alignbit_b32 v158, v87, v82, 16
    v_bfi_b32 v162, s55, v83, v87
    v_alignbit_b32 v166, v88, v83, 16
    v_bfi_b32 v170, s55, v84, v88
    v_alignbit_b32 v174, v89, v84, 16
    v_bfi_b32 v178, s55, v85, v89
    v_alignbit_b32 v182, v90, v85, 16
    v_bfi_b32 v186, s55, v86, v90
    s_waitcnt lgkmcnt(4)
    v_bfi_b32 v155, s55, v91, v95
    v_alignbit_b32 v159, v96, v91, 16
    v_bfi_b32 v163, s55, v92, v96
    v_alignbit_b32 v167, v97, v92, 16
    v_bfi_b32 v171, s55, v93, v97
    v_alignbit_b32 v175, v98, v93, 16
    v_bfi_b32 v179, s55, v94, v98
    v_alignbit_b32 v183, v99, v94, 16
    v_bfi_b32 v187, s55, v95, v99
    s_waitcnt lgkmcnt(2)
    v_bfi_b32 v156, s55, v100, v104
    v_alignbit_b32 v160, v105, v100, 16
    v_bfi_b32 v164, s55, v101, v105
    v_alignbit_b32 v168, v106, v101, 16
    v_bfi_b32 v172, s55, v102, v106
    v_alignbit_b32 v176, v107, v102, 16
    v_bfi_b32 v180, s55, v103, v107
    v_alignbit_b32 v184, v108, v103, 16
    v_bfi_b32 v188, s55, v104, v108
    s_waitcnt lgkmcnt(0)
    v_bfi_b32 v157, s55, v109, v113
    v_alignbit_b32 v161, v114, v109, 16
    v_bfi_b32 v165, s55, v110, v114
    v_alignbit_b32 v169, v115, v110, 16
    v_bfi_b32 v173, s55, v111, v115
    v_alignbit_b32 v177, v116, v111, 16
    v_bfi_b32 v181, s55, v112, v116
    v_alignbit_b32 v185, v117, v112, 16
    v_bfi_b32 v189, s55, v113, v117
    ds_read_b128 v[82:85], v78 offset:0
    ds_read_b128 v[86:89], v79 offset:0
    ds_read_b128 v[90:93], v80 offset:0
    ds_read_b128 v[94:97], v81 offset:0
    ds_read_b128 v[98:101], v74 offset:1024
    ds_read_b128 v[102:105], v75 offset:1024
    ds_read_b128 v[106:109], v76 offset:1024
    ds_read_b128 v[110:113], v77 offset:1024
    ds_read_b128 v[114:117], v74 offset:2048
    s_waitcnt vmcnt(0)
    s_barrier
    s_cmp_lg_u32 s44, 0
    s_cbranch_scc1 L_nf7a0000
    s_lshl_b32 s68, s84, 7
    s_add_u32 s68, s68, 7995392
    v_mov_b32 v8, s54
    v_mov_b32 v9, s54
    v_mov_b32 v10, s54
    v_mov_b32 v11, s54
    v_cmp_gt_u32 vcc, 8, v2
    s_and_saveexec_b64 s[90:91], vcc
    buffer_store_dwordx4 v[8:11], v31, s[28:31], s68 offen sc1
    s_mov_b64 exec, s[90:91]
L_nf7a0000:
    s_add_u32 m0, s53, 10240
    s_nop 0
    buffer_load_dwordx4 v65, s[96:99], s59 offen offset:1024 lds
    buffer_load_dwordx4 v66, s[96:99], s59 offen offset:2048 lds
    buffer_load_dwordx4 v67, s[96:99], s59 offen offset:3072 lds
    s_add_u32 m0, s53, 14336
    s_nop 0
    buffer_load_dwordx4 v68, s[96:99], s59 offen offset:0 lds
    buffer_load_dwordx4 v69, s[96:99], s59 offen offset:1024 lds
    buffer_load_dwordx4 v70, s[96:99], s59 offen offset:2048 lds
    buffer_load_dwordx4 v71, s[96:99], s59 offen offset:3072 lds
    s_add_u32 m0, s53, 18432
    s_nop 0
    buffer_load_dwordx4 v72, s[96:99], s59 offen offset:0 lds
    s_waitcnt lgkmcnt(0)
    s_add_u32 m0, s53, 0
    s_nop 0
    buffer_load_dwordx4 v64, s[96:99], s60 offen offset:0 lds
    buffer_load_dwordx4 v65, s[96:99], s60 offen offset:1024 lds
    buffer_load_dwordx4 v66, s[96:99], s60 offen offset:2048 lds
    buffer_load_dwordx4 v67, s[96:99], s60 offen offset:3072 lds
    s_add_u32 m0, s53, 4096
    s_nop 0
    buffer_load_dwordx4 v68, s[96:99], s60 offen offset:0 lds
    buffer_load_dwordx4 v69, s[96:99], s60 offen offset:1024 lds
    buffer_load_dwordx4 v70, s[96:99], s60 offen offset:2048 lds
    buffer_load_dwordx4 v71, s[96:99], s60 offen offset:3072 lds
    s_add_u32 m0, s53, 8192
    s_nop 0
    buffer_load_dwordx4 v72, s[96:99], s60 offen offset:0 lds
    buffer_load_dwordx4 v73, s[96:99], s60 offen offset:1024 lds
    s_mov_b32 s69, 0
    s_mov_b32 s68, 7995392
L_p4:
    buffer_load_dword v5, v50, s[28:31], s68 offen sc1
    s_waitcnt vmcnt(0)
    v_cmp_eq_u32 vcc, s54, v5
    s_add_u32 s69, s69, 1
    s_cmp_eq_u64 vcc, exec
    s_cbranch_scc1 L_p4ok
    s_cmp_lt_u32 s69, 0x40000
    s_cbranch_scc1 L_p4
L_p4ok:
    s_add_u32 m0, s53, 20480
    s_add_u32 s77, s64, 4259840
    buffer_load_dwordx4 v16, s[28:31], s77 offen offset:0 lds
    buffer_load_dwordx4 v17, s[28:31], s77 offen offset:1024 lds
    buffer_load_dwordx4 v18, s[28:31], s77 offen offset:2048 lds
    buffer_load_dwordx4 v19, s[28:31], s77 offen offset:3072 lds
    s_add_u32 m0, s53, 24576
    s_nop 0
    buffer_load_dwordx4 v20, s[28:31], s77 offen offset:0 lds
    buffer_load_dwordx4 v21, s[28:31], s77 offen offset:1024 lds
    buffer_load_dwordx4 v22, s[28:31], s77 offen offset:2048 lds
    buffer_load_dwordx4 v23, s[28:31], s77 offen offset:3072 lds
    s_add_u32 m0, s53, 28672
    s_nop 0
    buffer_load_dwordx4 v24, s[28:31], s77 offen offset:0 lds
    buffer_load_dwordx4 v25, s[28:31], s77 offen offset:1024 lds
    buffer_load_dwordx4 v26, s[28:31], s77 offen offset:2048 lds
    buffer_load_dwordx4 v27, s[28:31], s77 offen offset:3072 lds
    s_waitcnt vmcnt(8)
    ds_read_b128 a[64:67], v29 offset:0
    ds_read_b128 a[68:71], v28 offset:0
    ds_read_b128 a[72:75], v28 offset:16
    ds_read_b128 a[76:79], v28 offset:240
    ds_read_b128 a[80:83], v28 offset:256
    ds_read_b128 a[84:87], v30 offset:272
    ds_read_b128 a[88:91], v29 offset:512
    ds_read_b128 a[92:95], v28 offset:512
    ds_read_b128 a[96:99], v28 offset:528
    ds_read_b128 a[100:103], v28 offset:752
    ds_read_b128 a[104:107], v28 offset:768
    ds_read_b128 a[108:111], v30 offset:784
    s_waitcnt vmcnt(4)
    ds_read_b128 a[112:115], v29 offset:4096
    ds_read_b128 a[116:119], v28 offset:4096
    ds_read_b128 a[120:123], v28 offset:4112
    ds_read_b128 a[124:127], v28 offset:4336
    ds_read_b128 a[128:131], v28 offset:4352
    ds_read_b128 a[132:135], v30 offset:4368
    s_waitcnt lgkmcnt(15)
    v_mfma_f32_16x16x32_bf16 a[0:3], a[64:67], v[118:121], 0
    v_mfma_f32_16x16x32_bf16 a[0:3], a[68:71], v[122:125], a[0:3]
    ds_read_b128 a[136:139], v29 offset:4608
    v_mfma_f32_16x16x32_bf16 a[0:3], a[72:75], v[126:129], a[0:3]
    ds_read_b128 a[140:143], v28 offset:4608
    s_waitcnt lgkmcnt(11)
    v_mfma_f32_16x16x32_bf16 a[0:3], a[88:91], v[130:133], a[0:3]
    s_add_u32 m0, s53, 32768
    s_add_u32 s77, s65, 4259840
    v_mfma_f32_16x16x32_bf16 a[0:3], a[92:95], v[134:137], a[0:3]
    ds_read_b128 a[144:147], v28 offset:4624
    v_mfma_f32_16x16x32_bf16 a[0:3], a[96:99], v[138:141], a[0:3]
    s_waitcnt lgkmcnt(6)
    v_mfma_f32_16x16x32_bf16 a[0:3], a[112:115], v[142:145], a[0:3]
    buffer_load_dwordx4 v16, s[28:31], s77 offen offset:0 lds
    v_mfma_f32_16x16x32_bf16 a[0:3], a[116:119], v[146:149], a[0:3]
    ds_read_b128 a[148:151], v28 offset:4848
    v_mfma_f32_16x16x32_bf16 a[0:3], a[120:123], v[150:153], a[0:3]
    s_mov_b32 s36, s22
    s_and_b32 s37, s23, 0xffff
    v_mfma_f32_16x16x32_bf16 a[4:7], a[76:79], v[118:121], 0
    ds_read_b128 a[152:155], v28 offset:4864
    ds_read_b128 a[156:159], v30 offset:4880
    v_mfma_f32_16x16x32_bf16 a[4:7], a[80:83], v[122:125], a[4:7]
    buffer_load_dwordx4 v17, s[28:31], s77 offen offset:1024 lds
    v_mfma_f32_16x16x32_bf16 a[4:7], a[84:87], v[126:129], a[4:7]
    s_mov_b32 s38, 2097152
    s_mov_b32 s39, 0x20000
    v_mfma_f32_16x16x32_bf16 a[4:7], a[100:103], v[130:133], a[4:7]
    v_lshlrev_b32 v48, 11, v3
    v_lshl_add_u32 v48, v4, 3, v48
    v_mfma_f32_16x16x32_bf16 a[4:7], a[104:107], v[134:137], a[4:7]
    v_mfma_f32_16x16x32_bf16 a[4:7], a[108:111], v[138:141], a[4:7]
    s_waitcnt lgkmcnt(6)
    v_mfma_f32_16x16x32_bf16 a[4:7], a[124:127], v[142:145], a[4:7]
    buffer_load_dwordx4 v18, s[28:31], s77 offen offset:2048 lds
    v_mfma_f32_16x16x32_bf16 a[4:7], a[128:131], v[146:149], a[4:7]
    s_lshl_b32 s68, s47, 20
    s_lshl_b32 s69, s51, 11
    v_mfma_f32_16x16x32_bf16 a[4:7], a[132:135], v[150:153], a[4:7]
    v_mfma_f32_16x16x32_bf16 a[8:11], a[88:91], v[118:121], 0
    s_add_u32 s68, s68, s69
    s_add_u32 s69, s52, s44
    v_mfma_f32_16x16x32_bf16 a[8:11], a[92:95], v[122:125], a[8:11]
    v_mfma_f32_16x16x32_bf16 a[8:11], a[96:99], v[126:129], a[8:11]
    buffer_load_dwordx4 v19, s[28:31], s77 offen offset:3072 lds
    v_mfma_f32_16x16x32_bf16 a[8:11], a[112:115], v[130:133], a[8:11]
    s_lshl_b32 s69, s69, 6
    s_add_u32 s88, s68, s69
    v_mfma_f32_16x16x32_bf16 a[8:11], a[116:119], v[134:137], a[8:11]
    v_mfma_f32_16x16x32_bf16 a[8:11], a[120:123], v[138:141], a[8:11]
    s_waitcnt lgkmcnt(3)
    v_mfma_f32_16x16x32_bf16 a[8:11], a[136:139], v[142:145], a[8:11]
    s_waitcnt vmcnt(4)
    ds_read_b128 a[160:163], v29 offset:8192
    v_mfma_f32_16x16x32_bf16 a[8:11], a[140:143], v[146:149], a[8:11]
    ds_read_b128 a[164:167], v28 offset:8192
    s_add_u32 s89, s88, 32768
    v_mfma_f32_16x16x32_bf16 a[8:11], a[144:147], v[150:153], a[8:11]
    s_add_u32 m0, s53, 36864
    ds_read_b128 a[168:171], v28 offset:8208
    v_mfma_f32_16x16x32_bf16 a[12:15], a[100:103], v[118:121], 0
    buffer_load_dwordx4 v20, s[28:31], s77 offen offset:0 lds
    v_mfma_f32_16x16x32_bf16 a[12:15], a[104:107], v[122:125], a[12:15]
    ds_read_b128 a[172:175], v28 offset:8432
    v_mfma_f32_16x16x32_bf16 a[12:15], a[108:111], v[126:129], a[12:15]
    buffer_load_dwordx2 v[32:33], v48, s[32:35], s88 offen offset:0
    v_mfma_f32_16x16x32_bf16 a[12:15], a[124:127], v[130:133], a[12:15]
    ds_read_b128 a[176:179], v28 offset:8448
    ds_read_b128 a[180:183], v30 offset:8464
    v_mfma_f32_16x16x32_bf16 a[12:15], a[128:131], v[134:137], a[12:15]
    buffer_load_dwordx2 v[34:35], v48, s[32:35], s88 offen offset:32
    v_mfma_f32_16x16x32_bf16 a[12:15], a[132:135], v[138:141], a[12:15]
    s_waitcnt lgkmcnt(6)
    v_mfma_f32_16x16x32_bf16 a[12:15], a[148:151], v[142:145], a[12:15]
    buffer_load_dwordx4 v21, s[28:31], s77 offen offset:1024 lds
    v_mfma_f32_16x16x32_bf16 a[12:15], a[152:155], v[146:149], a[12:15]
    buffer_load_dwordx2 v[36:37], v48, s[32:35], s89 offen offset:0
    v_mfma_f32_16x16x32_bf16 a[12:15], a[156:159], v[150:153], a[12:15]
    v_mfma_f32_16x16x32_bf16 a[16:19], a[112:115], v[118:121], 0
    buffer_load_dwordx2 v[38:39], v48, s[32:35], s89 offen offset:32
    v_mfma_f32_16x16x32_bf16 a[16:19], a[116:119], v[122:125], a[16:19]
    buffer_load_dwordx4 v22, s[28:31], s77 offen offset:2048 lds
    v_mfma_f32_16x16x32_bf16 a[16:19], a[120:123], v[126:129], a[16:19]
    v_mfma_f32_16x16x32_bf16 a[16:19], a[136:139], v[130:133], a[16:19]
    v_mfma_f32_16x16x32_bf16 a[16:19], a[140:143], v[134:137], a[16:19]
    v_mfma_f32_16x16x32_bf16 a[16:19], a[144:147], v[138:141], a[16:19]
    ds_read_b128 a[184:187], v29 offset:8704
    s_waitcnt lgkmcnt(4)
    v_mfma_f32_16x16x32_bf16 a[16:19], a[160:163], v[142:145], a[16:19]
    ds_read_b128 a[188:191], v28 offset:8704
    v_mfma_f32_16x16x32_bf16 a[16:19], a[164:167], v[146:149], a[16:19]
    buffer_load_dwordx4 v23, s[28:31], s77 offen offset:3072 lds
    v_mfma_f32_16x16x32_bf16 a[16:19], a[168:171], v[150:153], a[16:19]
    ds_read_b128 a[192:195], v28 offset:8720
    v_mfma_f32_16x16x32_bf16 a[20:23], a[124:127], v[118:121], 0
    ds_read_b128 a[196:199], v28 offset:8944
    v_mfma_f32_16x16x32_bf16 a[20:23], a[128:131], v[122:125], a[20:23]
    v_mfma_f32_16x16x32_bf16 a[20:23], a[132:135], v[126:129], a[20:23]
    ds_read_b128 a[200:203], v28 offset:8960
    s_add_u32 m0, s53, 20480
    v_mfma_f32_16x16x32_bf16 a[20:23], a[148:151], v[130:133], a[20:23]
    ds_read_b128 a[204:207], v30 offset:8976
    v_mfma_f32_16x16x32_bf16 a[20:23], a[152:155], v[134:137], a[20:23]
    buffer_load_dwordx4 v24, s[28:31], s77 offen offset:0 lds
    v_mfma_f32_16x16x32_bf16 a[20:23], a[156:159], v[138:141], a[20:23]
    s_waitcnt lgkmcnt(6)
    v_mfma_f32_16x16x32_bf16 a[20:23], a[172:175], v[142:145], a[20:23]
    v_mfma_f32_16x16x32_bf16 a[20:23], a[176:179], v[146:149], a[20:23]
    v_mfma_f32_16x16x32_bf16 a[20:23], a[180:183], v[150:153], a[20:23]
    buffer_load_dwordx4 v25, s[28:31], s77 offen offset:1024 lds
    v_mfma_f32_16x16x32_bf16 a[24:27], a[136:139], v[118:121], 0
    v_mfma_f32_16x16x32_bf16 a[24:27], a[140:143], v[122:125], a[24:27]
    v_mfma_f32_16x16x32_bf16 a[24:27], a[144:147], v[126:129], a[24:27]
    v_mfma_f32_16x16x32_bf16 a[24:27], a[160:163], v[130:133], a[24:27]
    v_mfma_f32_16x16x32_bf16 a[24:27], a[164:167], v[134:137], a[24:27]
    v_mfma_f32_16x16x32_bf16 a[24:27], a[168:171], v[138:141], a[24:27]
    s_waitcnt lgkmcnt(3)
    v_mfma_f32_16x16x32_bf16 a[24:27], a[184:187], v[142:145], a[24:27]
    buffer_load_dwordx4 v26, s[28:31], s77 offen offset:2048 lds
    v_mfma_f32_16x16x32_bf16 a[24:27], a[188:191], v[146:149], a[24:27]
    v_mfma_f32_16x16x32_bf16 a[24:27], a[192:195], v[150:153], a[24:27]
    v_mfma_f32_16x16x32_bf16 a[28:31], a[148:151], v[118:121], 0
    v_mfma_f32_16x16x32_bf16 a[28:31], a[152:155], v[122:125], a[28:31]
    buffer_load_dwordx4 v27, s[28:31], s77 offen offset:3072 lds
    v_mfma_f32_16x16x32_bf16 a[28:31], a[156:159], v[126:129], a[28:31]
    v_mfma_f32_16x16x32_bf16 a[28:31], a[172:175], v[130:133], a[28:31]
    v_mfma_f32_16x16x32_bf16 a[28:31], a[176:179], v[134:137], a[28:31]
    v_mfma_f32_16x16x32_bf16 a[28:31], a[180:183], v[138:141], a[28:31]
    s_waitcnt lgkmcnt(0)
    v_mfma_f32_16x16x32_bf16 a[28:31], a[196:199], v[142:145], a[28:31]
    s_add_u32 m0, s53, 24576
    s_add_u32 s77, s66, 4259840
    v_mfma_f32_16x16x32_bf16 a[28:31], a[200:203], v[146:149], a[28:31]
    buffer_load_dwordx4 v16, s[28:31], s77 offen offset:0 lds
    v_mfma_f32_16x16x32_bf16 a[28:31], a[204:207], v[150:153], a[28:31]
    v_mfma_f32_16x16x32_bf16 a[32:35], a[64:67], v[154:157], 0
    v_mfma_f32_16x16x32_bf16 a[32:35], a[68:71], v[158:161], a[32:35]
    v_bfi_b32 v118, s55, v82, v86
    v_mfma_f32_16x16x32_bf16 a[32:35], a[72:75], v[162:165], a[32:35]
    v_alignbit_b32 v122, v87, v82, 16
    v_mfma_f32_16x16x32_bf16 a[32:35], a[88:91], v[166:169], a[32:35]
    v_bfi_b32 v126, s55, v83, v87
    v_mfma_f32_16x16x32_bf16 a[32:35], a[92:95], v[170:173], a[32:35]
    buffer_load_dwordx4 v17, s[28:31], s77 offen offset:1024 lds
    v_mfma_f32_16x16x32_bf16 a[32:35], a[96:99], v[174:177], a[32:35]
    v_alignbit_b32 v130, v88, v83, 16
    v_mfma_f32_16x16x32_bf16 a[32:35], a[112:115], v[178:181], a[32:35]
    v_bfi_b32 v134, s55, v84, v88
    v_mfma_f32_16x16x32_bf16 a[32:35], a[116:119], v[182:185], a[32:35]
    v_alignbit_b32 v138, v89, v84, 16
    v_mfma_f32_16x16x32_bf16 a[32:35], a[120:123], v[186:189], a[32:35]
    v_mfma_f32_16x16x32_bf16 a[36:39], a[76:79], v[154:157], 0
    v_bfi_b32 v142, s55, v85, v89
    v_mfma_f32_16x16x32_bf16 a[36:39], a[80:83], v[158:161], a[36:39]
    buffer_load_dwordx4 v18, s[28:31], s77 offen offset:2048 lds
    v_mfma_f32_16x16x32_bf16 a[36:39], a[84:87], v[162:165], a[36:39]
    v_alignbit_b32 v146, v90, v85, 16
    v_bfi_b32 v150, s55, v86, v90
    v_mfma_f32_16x16x32_bf16 a[36:39], a[100:103], v[166:169], a[36:39]
    v_mfma_f32_16x16x32_bf16 a[36:39], a[104:107], v[170:173], a[36:39]
    v_bfi_b32 v119, s55, v91, v95
    v_mfma_f32_16x16x32_bf16 a[36:39], a[108:111], v[174:177], a[36:39]
    v_alignbit_b32 v123, v96, v91, 16
    v_mfma_f32_16x16x32_bf16 a[36:39], a[124:127], v[178:181], a[36:39]
    buffer_load_dwordx4 v19, s[28:31], s77 offen offset:3072 lds
    v_mfma_f32_16x16x32_bf16 a[36:39], a[128:131], v[182:185], a[36:39]
    v_bfi_b32 v127, s55, v92, v96
    v_mfma_f32_16x16x32_bf16 a[36:39], a[132:135], v[186:189], a[36:39]
    v_alignbit_b32 v131, v97, v92, 16
    v_mfma_f32_16x16x32_bf16 a[40:43], a[88:91], v[154:157], 0
    v_bfi_b32 v135, s55, v93, v97
    v_mfma_f32_16x16x32_bf16 a[40:43], a[92:95], v[158:161], a[40:43]
    s_waitcnt vmcnt(16)
    ds_read_b128 a[64:67], v29 offset:12288
    v_mfma_f32_16x16x32_bf16 a[40:43], a[96:99], v[162:165], a[40:43]
    v_alignbit_b32 v139, v98, v93, 16
    s_add_u32 m0, s53, 28672
    v_mfma_f32_16x16x32_bf16 a[40:43], a[112:115], v[166:169], a[40:43]
    ds_read_b128 a[68:71], v28 offset:12288
    v_mfma_f32_16x16x32_bf16 a[40:43], a[116:119], v[170:173], a[40:43]
    buffer_load_dwordx4 v20, s[28:31], s77 offen offset:0 lds
    v_mfma_f32_16x16x32_bf16 a[40:43], a[120:123], v[174:177], a[40:43]
    v_bfi_b32 v143, s55, v94, v98
    ds_read_b128 a[72:75], v28 offset:12304
    v_mfma_f32_16x16x32_bf16 a[40:43], a[136:139], v[178:181], a[40:43]
    v_alignbit_b32 v147, v99, v94, 16
    ds_read_b128 a[76:79], v28 offset:12528
    v_mfma_f32_16x16x32_bf16 a[40:43], a[140:143], v[182:185], a[40:43]
    v_bfi_b32 v151, s55, v95, v99
    ds_read_b128 a[80:83], v28 offset:12544
    v_mfma_f32_16x16x32_bf16 a[40:43], a[144:147], v[186:189], a[40:43]
    v_bfi_b32 v120, s55, v100, v104
    v_mfma_f32_16x16x32_bf16 a[44:47], a[100:103], v[154:157], 0
    buffer_load_dwordx4 v21, s[28:31], s77 offen offset:1024 lds
    v_mfma_f32_16x16x32_bf16 a[44:47], a[104:107], v[158:161], a[44:47]
    ds_read_b128 a[84:87], v30 offset:12560
    v_alignbit_b32 v124, v105, v100, 16
    v_mfma_f32_16x16x32_bf16 a[44:47], a[108:111], v[162:165], a[44:47]
    v_bfi_b32 v128, s55, v101, v105
    v_alignbit_b32 v132, v106, v101, 16
    v_mfma_f32_16x16x32_bf16 a[44:47], a[124:127], v[166:169], a[44:47]
    v_bfi_b32 v136, s55, v102, v106
    v_mfma_f32_16x16x32_bf16 a[44:47], a[128:131], v[170:173], a[44:47]
    v_alignbit_b32 v140, v107, v102, 16
    v_mfma_f32_16x16x32_bf16 a[44:47], a[132:135], v[174:177], a[44:47]
    buffer_load_dwordx4 v22, s[28:31], s77 offen offset:2048 lds
    v_mfma_f32_16x16x32_bf16 a[44:47], a[148:151], v[178:181], a[44:47]
    v_bfi_b32 v144, s55, v103, v107
    v_mfma_f32_16x16x32_bf16 a[44:47], a[152:155], v[182:185], a[44:47]
    v_alignbit_b32 v148, v108, v103, 16
    v_mfma_f32_16x16x32_bf16 a[44:47], a[156:159], v[186:189], a[44:47]
    v_bfi_b32 v152, s55, v104, v108
    v_mfma_f32_16x16x32_bf16 a[48:51], a[112:115], v[154:157], 0
    buffer_load_dwordx4 v23, s[28:31], s77 offen offset:3072 lds
    v_mfma_f32_16x16x32_bf16 a[48:51], a[116:119], v[158:161], a[48:51]
    ds_read_b128 a[88:91], v29 offset:12800
    v_bfi_b32 v121, s55, v109, v113
    v_mfma_f32_16x16x32_bf16 a[48:51], a[120:123], v[162:165], a[48:51]
    ds_read_b128 a[92:95], v28 offset:12800
    v_alignbit_b32 v125, v114, v109, 16
    v_mfma_f32_16x16x32_bf16 a[48:51], a[136:139], v[166:169], a[48:51]
    v_bfi_b32 v129, s55, v110, v114
    v_mfma_f32_16x16x32_bf16 a[48:51], a[140:143], v[170:173], a[48:51]
    ds_read_b128 a[96:99], v28 offset:12816
    v_mfma_f32_16x16x32_bf16 a[48:51], a[144:147], v[174:177], a[48:51]
    ds_read_b128 a[100:103], v28 offset:13040
    v_alignbit_b32 v133, v115, v110, 16
    v_mfma_f32_16x16x32_bf16 a[48:51], a[160:163], v[178:181], a[48:51]
    v_bfi_b32 v137, s55, v111, v115
    v_mfma_f32_16x16x32_bf16 a[48:51], a[164:167], v[182:185], a[48:51]
    ds_read_b128 a[104:107], v28 offset:13056
    v_alignbit_b32 v141, v116, v111, 16
    v_mfma_f32_16x16x32_bf16 a[48:51], a[168:171], v[186:189], a[48:51]
    ds_read_b128 a[108:111], v30 offset:13072
    v_mfma_f32_16x16x32_bf16 a[52:55], a[124:127], v[154:157], 0
    v_bfi_b32 v145, s55, v112, v116
    v_mfma_f32_16x16x32_bf16 a[52:55], a[128:131], v[158:161], a[52:55]
    v_alignbit_b32 v149, v117, v112, 16
    v_mfma_f32_16x16x32_bf16 a[52:55], a[132:135], v[162:165], a[52:55]
    v_bfi_b32 v153, s55, v113, v117
    v_mfma_f32_16x16x32_bf16 a[52:55], a[148:151], v[166:169], a[52:55]
    v_mfma_f32_16x16x32_bf16 a[52:55], a[152:155], v[170:173], a[52:55]
    s_waitcnt lgkmcnt(0)
    s_add_u32 m0, s53, 32768
    v_mfma_f32_16x16x32_bf16 a[52:55], a[156:159], v[174:177], a[52:55]
    buffer_load_dwordx4 v24, s[28:31], s77 offen offset:0 lds
    v_mfma_f32_16x16x32_bf16 a[52:55], a[172:175], v[178:181], a[52:55]
    v_mfma_f32_16x16x32_bf16 a[52:55], a[176:179], v[182:185], a[52:55]
    ds_read_b128 v[82:85], v78 offset:10240
    v_mfma_f32_16x16x32_bf16 a[52:55], a[180:183], v[186:189], a[52:55]
    v_mfma_f32_16x16x32_bf16 a[56:59], a[136:139], v[154:157], 0
    ds_read_b128 v[86:89], v79 offset:10240
    v_mfma_f32_16x16x32_bf16 a[56:59], a[140:143], v[158:161], a[56:59]
    s_waitcnt vmcnt(13)
    ds_read_b128 a[112:115], v29 offset:16384
    v_mfma_f32_16x16x32_bf16 a[56:59], a[144:147], v[162:165], a[56:59]
    buffer_load_dwordx4 v25, s[28:31], s77 offen offset:1024 lds
    v_mfma_f32_16x16x32_bf16 a[56:59], a[160:163], v[166:169], a[56:59]
    ds_read_b128 a[116:119], v28 offset:16384
    ds_read_b128 v[90:93], v80 offset:10240
    v_mfma_f32_16x16x32_bf16 a[56:59], a[164:167], v[170:173], a[56:59]
    ds_read_b128 a[120:123], v28 offset:16400
    ds_read_b128 v[94:97], v81 offset:10240
    v_mfma_f32_16x16x32_bf16 a[56:59], a[168:171], v[174:177], a[56:59]
    ds_read_b128 a[124:127], v28 offset:16624
    v_mfma_f32_16x16x32_bf16 a[56:59], a[184:187], v[178:181], a[56:59]
    ds_read_b128 v[98:101], v74 offset:11264
    v_mfma_f32_16x16x32_bf16 a[56:59], a[188:191], v[182:185], a[56:59]
    ds_read_b128 a[128:131], v28 offset:16640
    v_mfma_f32_16x16x32_bf16 a[56:59], a[192:195], v[186:189], a[56:59]
    buffer_load_dwordx4 v26, s[28:31], s77 offen offset:2048 lds
    v_mfma_f32_16x16x32_bf16 a[60:63], a[148:151], v[154:157], 0
    ds_read_b128 a[132:135], v30 offset:16656
    ds_read_b128 v[102:105], v75 offset:11264
    v_mfma_f32_16x16x32_bf16 a[60:63], a[152:155], v[158:161], a[60:63]
    ds_read_b128 v[106:109], v76 offset:11264
    v_mfma_f32_16x16x32_bf16 a[60:63], a[156:159], v[162:165], a[60:63]
    v_mfma_f32_16x16x32_bf16 a[60:63], a[172:175], v[166:169], a[60:63]
    ds_read_b128 v[110:113], v77 offset:11264
    v_mfma_f32_16x16x32_bf16 a[60:63], a[176:179], v[170:173], a[60:63]
    buffer_load_dwordx4 v27, s[28:31], s77 offen offset:3072 lds
    v_mfma_f32_16x16x32_bf16 a[60:63], a[180:183], v[174:177], a[60:63]
    ds_read_b128 v[114:117], v74 offset:12288
    v_mfma_f32_16x16x32_bf16 a[60:63], a[196:199], v[178:181], a[60:63]
    v_mfma_f32_16x16x32_bf16 a[60:63], a[200:203], v[182:185], a[60:63]
    v_mfma_f32_16x16x32_bf16 a[60:63], a[204:207], v[186:189], a[60:63]
    v_mfma_f32_16x16x32_bf16 a[0:3], a[64:67], v[118:121], a[0:3]
    v_mfma_f32_16x16x32_bf16 a[0:3], a[68:71], v[122:125], a[0:3]
    ds_read_b128 a[136:139], v29 offset:16896
    v_mfma_f32_16x16x32_bf16 a[0:3], a[72:75], v[126:129], a[0:3]
    s_waitcnt lgkmcnt(11)
    v_bfi_b32 v154, s55, v82, v86
    v_mfma_f32_16x16x32_bf16 a[0:3], a[88:91], v[130:133], a[0:3]
    s_waitcnt lgkmcnt(1)
    s_add_u32 m0, s53, 10240
    v_mfma_f32_16x16x32_bf16 a[0:3], a[92:95], v[134:137], a[0:3]
    ds_read_b128 a[140:143], v28 offset:16896
    v_alignbit_b32 v158, v87, v82, 16
    v_mfma_f32_16x16x32_bf16 a[0:3], a[96:99], v[138:141], a[0:3]
    buffer_load_dwordx4 v64, s[96:99], s61 offen offset:0 lds
    v_mfma_f32_16x16x32_bf16 a[0:3], a[112:115], v[142:145], a[0:3]
    v_bfi_b32 v162, s55, v83, v87
    ds_read_b128 a[144:147], v28 offset:16912
    v_mfma_f32_16x16x32_bf16 a[0:3], a[116:119], v[146:149], a[0:3]
    ds_read_b128 a[148:151], v28 offset:17136
    v_alignbit_b32 v166, v88, v83, 16
    v_mfma_f32_16x16x32_bf16 a[0:3], a[120:123], v[150:153], a[0:3]
    v_bfi_b32 v170, s55, v84, v88
    ds_read_b128 a[152:155], v28 offset:17152
    v_mfma_f32_16x16x32_bf16 a[4:7], a[76:79], v[118:121], a[4:7]
    v_alignbit_b32 v174, v89, v84, 16
    v_mfma_f32_16x16x32_bf16 a[4:7], a[80:83], v[122:125], a[4:7]
    buffer_load_dwordx4 v65, s[96:99], s61 offen offset:1024 lds
    v_mfma_f32_16x16x32_bf16 a[4:7], a[84:87], v[126:129], a[4:7]
    ds_read_b128 a[156:159], v30 offset:17168
    v_bfi_b32 v178, s55, v85, v89
    v_mfma_f32_16x16x32_bf16 a[4:7], a[100:103], v[130:133], a[4:7]
    v_alignbit_b32 v182, v90, v85, 16
    v_bfi_b32 v186, s55, v86, v90
    v_mfma_f32_16x16x32_bf16 a[4:7], a[104:107], v[134:137], a[4:7]
    v_bfi_b32 v155, s55, v91, v95
    v_mfma_f32_16x16x32_bf16 a[4:7], a[108:111], v[138:141], a[4:7]
    buffer_load_dwordx4 v66, s[96:99], s61 offen offset:2048 lds
    v_mfma_f32_16x16x32_bf16 a[4:7], a[124:127], v[142:145], a[4:7]
    v_alignbit_b32 v159, v96, v91, 16
    v_bfi_b32 v163, s55, v92, v96
    v_mfma_f32_16x16x32_bf16 a[4:7], a[128:131], v[146:149], a[4:7]
    v_mfma_f32_16x16x32_bf16 a[4:7], a[132:135], v[150:153], a[4:7]
    v_alignbit_b32 v167, v97, v92, 16
    v_mfma_f32_16x16x32_bf16 a[8:11], a[88:91], v[118:121], a[8:11]
    v_bfi_b32 v171, s55, v93, v97
    v_mfma_f32_16x16x32_bf16 a[8:11], a[92:95], v[122:125], a[8:11]
    buffer_load_dwordx4 v67, s[96:99], s61 offen offset:3072 lds
    v_mfma_f32_16x16x32_bf16 a[8:11], a[96:99], v[126:129], a[8:11]
    v_alignbit_b32 v175, v98, v93, 16
    v_mfma_f32_16x16x32_bf16 a[8:11], a[112:115], v[130:133], a[8:11]
    v_bfi_b32 v179, s55, v94, v98
    v_mfma_f32_16x16x32_bf16 a[8:11], a[116:119], v[134:137], a[8:11]
    v_alignbit_b32 v183, v99, v94, 16
    v_mfma_f32_16x16x32_bf16 a[8:11], a[120:123], v[138:141], a[8:11]
    s_waitcnt lgkmcnt(3)
    v_mfma_f32_16x16x32_bf16 a[8:11], a[136:139], v[142:145], a[8:11]
    s_waitcnt vmcnt(16)
    ds_read_b128 a[160:163], v29 offset:0
    v_mfma_f32_16x16x32_bf16 a[8:11], a[140:143], v[146:149], a[8:11]
    v_bfi_b32 v187, s55, v95, v99
    s_add_u32 m0, s53, 14336
    v_mfma_f32_16x16x32_bf16 a[8:11], a[144:147], v[150:153], a[8:11]
    ds_read_b128 a[164:167], v28 offset:0
    v_mfma_f32_16x16x32_bf16 a[12:15], a[100:103], v[118:121], a[12:15]
    buffer_load_dwordx4 v68, s[96:99], s61 offen offset:0 lds
    v_mfma_f32_16x16x32_bf16 a[12:15], a[104:107], v[122:125], a[12:15]
    v_bfi_b32 v156, s55, v100, v104
    ds_read_b128 a[168:171], v28 offset:16
    v_mfma_f32_16x16x32_bf16 a[12:15], a[108:111], v[126:129], a[12:15]
    v_alignbit_b32 v160, v105, v100, 16
    ds_read_b128 a[172:175], v28 offset:240
    v_mfma_f32_16x16x32_bf16 a[12:15], a[124:127], v[130:133], a[12:15]
    v_bfi_b32 v164, s55, v101, v105
    ds_read_b128 a[176:179], v28 offset:256
    v_mfma_f32_16x16x32_bf16 a[12:15], a[128:131], v[134:137], a[12:15]
    v_alignbit_b32 v168, v106, v101, 16
    v_mfma_f32_16x16x32_bf16 a[12:15], a[132:135], v[138:141], a[12:15]
    s_waitcnt lgkmcnt(5)
    v_mfma_f32_16x16x32_bf16 a[12:15], a[148:151], v[142:145], a[12:15]
    buffer_load_dwordx4 v69, s[96:99], s61 offen offset:1024 lds
    v_mfma_f32_16x16x32_bf16 a[12:15], a[152:155], v[146:149], a[12:15]
    ds_read_b128 a[180:183], v30 offset:272
    v_bfi_b32 v172, s55, v102, v106
    v_mfma_f32_16x16x32_bf16 a[12:15], a[156:159], v[150:153], a[12:15]
    v_alignbit_b32 v176, v107, v102, 16
    v_bfi_b32 v180, s55, v103, v107
    v_mfma_f32_16x16x32_bf16 a[16:19], a[112:115], v[118:121], a[16:19]
    v_alignbit_b32 v184, v108, v103, 16
    v_bfi_b32 v188, s55, v104, v108
    v_mfma_f32_16x16x32_bf16 a[16:19], a[116:119], v[122:125], a[16:19]
    buffer_load_dwordx4 v70, s[96:99], s61 offen offset:2048 lds
    v_mfma_f32_16x16x32_bf16 a[16:19], a[120:123], v[126:129], a[16:19]
    v_bfi_b32 v157, s55, v109, v113
    v_alignbit_b32 v161, v114, v109, 16
    v_mfma_f32_16x16x32_bf16 a[16:19], a[136:139], v[130:133], a[16:19]
    v_bfi_b32 v165, s55, v110, v114
    v_mfma_f32_16x16x32_bf16 a[16:19], a[140:143], v[134:137], a[16:19]
    buffer_load_dwordx4 v71, s[96:99], s61 offen offset:3072 lds
    v_mfma_f32_16x16x32_bf16 a[16:19], a[144:147], v[138:141], a[16:19]
    ds_read_b128 a[184:187], v29 offset:512
    s_waitcnt lgkmcnt(4)
    v_mfma_f32_16x16x32_bf16 a[16:19], a[160:163], v[142:145], a[16:19]
    v_alignbit_b32 v169, v115, v110, 16
    ds_read_b128 a[188:191], v28 offset:512
    v_mfma_f32_16x16x32_bf16 a[16:19], a[164:167], v[146:149], a[16:19]
    v_bfi_b32 v173, s55, v111, v115
    v_alignbit_b32 v177, v116, v111, 16
    v_mfma_f32_16x16x32_bf16 a[16:19], a[168:171], v[150:153], a[16:19]
    ds_read_b128 a[192:195], v28 offset:528
    v_mfma_f32_16x16x32_bf16 a[20:23], a[124:127], v[118:121], a[20:23]
    ds_read_b128 a[196:199], v28 offset:752
    v_bfi_b32 v181, s55, v112, v116
    v_mfma_f32_16x16x32_bf16 a[20:23], a[128:131], v[122:125], a[20:23]
    s_add_u32 m0, s53, 18432
    v_alignbit_b32 v185, v117, v112, 16
    v_mfma_f32_16x16x32_bf16 a[20:23], a[132:135], v[126:129], a[20:23]
    buffer_load_dwordx4 v72, s[96:99], s61 offen offset:0 lds
    v_mfma_f32_16x16x32_bf16 a[20:23], a[148:151], v[130:133], a[20:23]
    ds_read_b128 a[200:203], v28 offset:768
    v_bfi_b32 v189, s55, v113, v117
    v_mfma_f32_16x16x32_bf16 a[20:23], a[152:155], v[134:137], a[20:23]
    ds_read_b128 a[204:207], v30 offset:784
    v_mfma_f32_16x16x32_bf16 a[20:23], a[156:159], v[138:141], a[20:23]
    s_waitcnt lgkmcnt(6)
    v_mfma_f32_16x16x32_bf16 a[20:23], a[172:175], v[142:145], a[20:23]
    buffer_load_dwordx4 v73, s[96:99], s61 offen offset:1024 lds
    v_mfma_f32_16x16x32_bf16 a[20:23], a[176:179], v[146:149], a[20:23]
    ds_read_b128 v[82:85], v74 offset:0
    v_mfma_f32_16x16x32_bf16 a[20:23], a[180:183], v[150:153], a[20:23]
    v_mfma_f32_16x16x32_bf16 a[24:27], a[136:139], v[118:121], a[24:27]
    ds_read_b128 v[86:89], v75 offset:0
    v_mfma_f32_16x16x32_bf16 a[24:27], a[140:143], v[122:125], a[24:27]
    v_mfma_f32_16x16x32_bf16 a[24:27], a[144:147], v[126:129], a[24:27]
    ds_read_b128 v[90:93], v76 offset:0
    v_mfma_f32_16x16x32_bf16 a[24:27], a[160:163], v[130:133], a[24:27]
    s_add_u32 m0, s53, 36864
    s_add_u32 s77, s67, 4259840
    v_mfma_f32_16x16x32_bf16 a[24:27], a[164:167], v[134:137], a[24:27]
    buffer_load_dwordx4 v16, s[28:31], s77 offen offset:0 lds
    v_mfma_f32_16x16x32_bf16 a[24:27], a[168:171], v[138:141], a[24:27]
    ds_read_b128 v[94:97], v77 offset:0
    s_waitcnt lgkmcnt(7)
    v_mfma_f32_16x16x32_bf16 a[24:27], a[184:187], v[142:145], a[24:27]
    ds_read_b128 v[98:101], v74 offset:1024
    v_mfma_f32_16x16x32_bf16 a[24:27], a[188:191], v[146:149], a[24:27]
    v_mfma_f32_16x16x32_bf16 a[24:27], a[192:195], v[150:153], a[24:27]
    ds_read_b128 v[102:105], v75 offset:1024
    v_mfma_f32_16x16x32_bf16 a[28:31], a[148:151], v[118:121], a[28:31]
    buffer_load_dwordx4 v17, s[28:31], s77 offen offset:1024 lds
    v_mfma_f32_16x16x32_bf16 a[28:31], a[152:155], v[122:125], a[28:31]
    ds_read_b128 v[106:109], v76 offset:1024
    v_mfma_f32_16x16x32_bf16 a[28:31], a[156:159], v[126:129], a[28:31]
    v_mfma_f32_16x16x32_bf16 a[28:31], a[172:175], v[130:133], a[28:31]
    ds_read_b128 v[110:113], v77 offset:1024
    v_mfma_f32_16x16x32_bf16 a[28:31], a[176:179], v[134:137], a[28:31]
    v_mfma_f32_16x16x32_bf16 a[28:31], a[180:183], v[138:141], a[28:31]
    ds_read_b128 v[114:117], v74 offset:2048
    s_waitcnt lgkmcnt(9)
    v_mfma_f32_16x16x32_bf16 a[28:31], a[196:199], v[142:145], a[28:31]
    buffer_load_dwordx4 v18, s[28:31], s77 offen offset:2048 lds
    v_mfma_f32_16x16x32_bf16 a[28:31], a[200:203], v[146:149], a[28:31]
    v_mfma_f32_16x16x32_bf16 a[28:31], a[204:207], v[150:153], a[28:31]
    v_mfma_f32_16x16x32_bf16 a[32:35], a[64:67], v[154:157], a[32:35]
    v_mfma_f32_16x16x32_bf16 a[32:35], a[68:71], v[158:161], a[32:35]
    s_waitcnt lgkmcnt(6)
    v_bfi_b32 v118, s55, v82, v86
    v_mfma_f32_16x16x32_bf16 a[32:35], a[72:75], v[162:165], a[32:35]
    buffer_load_dwordx4 v19, s[28:31], s77 offen offset:3072 lds
    v_mfma_f32_16x16x32_bf16 a[32:35], a[88:91], v[166:169], a[32:35]
    v_alignbit_b32 v122, v87, v82, 16
    v_bfi_b32 v126, s55, v83, v87
    v_mfma_f32_16x16x32_bf16 a[32:35], a[92:95], v[170:173], a[32:35]
    v_lshlrev_b32 v190, 16, v32
    v_mfma_f32_16x16x32_bf16 a[32:35], a[96:99], v[174:177], a[32:35]
    v_alignbit_b32 v130, v88, v83, 16
    v_mfma_f32_16x16x32_bf16 a[32:35], a[112:115], v[178:181], a[32:35]
    v_bfi_b32 v134, s55, v84, v88
    v_mfma_f32_16x16x32_bf16 a[32:35], a[116:119], v[182:185], a[32:35]
    s_waitcnt lgkmcnt(0)
    s_add_u32 m0, s53, 0
    v_mfma_f32_16x16x32_bf16 a[32:35], a[120:123], v[186:189], a[32:35]
    v_and_b32 v191, 0xffff0000, v32
    v_alignbit_b32 v138, v89, v84, 16
    v_mfma_f32_16x16x32_bf16 a[36:39], a[76:79], v[154:157], a[36:39]
    buffer_load_dwordx4 v65, s[96:99], s62 offen offset:1024 lds
    v_mfma_f32_16x16x32_bf16 a[36:39], a[80:83], v[158:161], a[36:39]
    v_bfi_b32 v142, s55, v85, v89
    v_lshlrev_b32 v192, 16, v33
    v_mfma_f32_16x16x32_bf16 a[36:39], a[84:87], v[162:165], a[36:39]
    v_alignbit_b32 v146, v90, v85, 16
    v_bfi_b32 v150, s55, v86, v90
    v_mfma_f32_16x16x32_bf16 a[36:39], a[100:103], v[166:169], a[36:39]
    buffer_load_dwordx4 v66, s[96:99], s62 offen offset:2048 lds
    v_mfma_f32_16x16x32_bf16 a[36:39], a[104:107], v[170:173], a[36:39]
    v_and_b32 v193, 0xffff0000, v33
    v_bfi_b32 v119, s55, v91, v95
    v_mfma_f32_16x16x32_bf16 a[36:39], a[108:111], v[174:177], a[36:39]
    v_alignbit_b32 v123, v96, v91, 16
    v_mfma_f32_16x16x32_bf16 a[36:39], a[124:127], v[178:181], a[36:39]
    v_bfi_b32 v127, s55, v92, v96
    v_lshlrev_b32 v194, 16, v34
    v_mfma_f32_16x16x32_bf16 a[36:39], a[128:131], v[182:185], a[36:39]
    v_mfma_f32_16x16x32_bf16 a[36:39], a[132:135], v[186:189], a[36:39]
    v_alignbit_b32 v131, v97, v92, 16
    v_mfma_f32_16x16x32_bf16 a[40:43], a[88:91], v[154:157], a[40:43]
    v_bfi_b32 v135, s55, v93, v97
    v_mfma_f32_16x16x32_bf16 a[40:43], a[92:95], v[158:161], a[40:43]
    buffer_load_dwordx4 v67, s[96:99], s62 offen offset:3072 lds
    v_mfma_f32_16x16x32_bf16 a[40:43], a[96:99], v[162:165], a[40:43]
    v_and_b32 v195, 0xffff0000, v34
    v_mfma_f32_16x16x32_bf16 a[40:43], a[112:115], v[166:169], a[40:43]
    s_waitcnt vmcnt(25)
    ds_read_b128 a[64:67], v29 offset:4096
    v_mfma_f32_16x16x32_bf16 a[40:43], a[116:119], v[170:173], a[40:43]
    v_alignbit_b32 v139, v98, v93, 16
    ds_read_b128 a[68:71], v28 offset:4096
    v_mfma_f32_16x16x32_bf16 a[40:43], a[120:123], v[174:177], a[40:43]
    v_bfi_b32 v143, s55, v94, v98
    v_lshlrev_b32 v196, 16, v35
    v_mfma_f32_16x16x32_bf16 a[40:43], a[136:139], v[178:181], a[40:43]
    ds_read_b128 a[72:75], v28 offset:4112
    v_alignbit_b32 v147, v99, v94, 16
    v_mfma_f32_16x16x32_bf16 a[40:43], a[140:143], v[182:185], a[40:43]
    s_add_u32 m0, s53, 4096
    ds_read_b128 a[76:79], v28 offset:4336
    v_mfma_f32_16x16x32_bf16 a[40:43], a[144:147], v[186:189], a[40:43]
    v_bfi_b32 v151, s55, v95, v99
    v_mfma_f32_16x16x32_bf16 a[44:47], a[100:103], v[154:157], a[44:47]
    buffer_load_dwordx4 v68, s[96:99], s62 offen offset:0 lds
    v_mfma_f32_16x16x32_bf16 a[44:47], a[104:107], v[158:161], a[44:47]
    v_and_b32 v197, 0xffff0000, v35
    ds_read_b128 a[80:83], v28 offset:4352
    v_mfma_f32_16x16x32_bf16 a[44:47], a[108:111], v[162:165], a[44:47]
    v_bfi_b32 v120, s55, v100, v104
    ds_read_b128 a[84:87], v30 offset:4368
    v_mfma_f32_16x16x32_bf16 a[44:47], a[124:127], v[166:169], a[44:47]
    v_alignbit_b32 v124, v105, v100, 16
    v_bfi_b32 v128, s55, v101, v105
    v_mfma_f32_16x16x32_bf16 a[44:47], a[128:131], v[170:173], a[44:47]
    v_lshlrev_b32 v198, 16, v36
    v_alignbit_b32 v132, v106, v101, 16
    v_mfma_f32_16x16x32_bf16 a[44:47], a[132:135], v[174:177], a[44:47]
    buffer_load_dwordx4 v69, s[96:99], s62 offen offset:1024 lds
    v_mfma_f32_16x16x32_bf16 a[44:47], a[148:151], v[178:181], a[44:47]
    v_bfi_b32 v136, s55, v102, v106
    v_and_b32 v199, 0xffff0000, v36
    v_mfma_f32_16x16x32_bf16 a[44:47], a[152:155], v[182:185], a[44:47]
    v_alignbit_b32 v140, v107, v102, 16
    v_bfi_b32 v144, s55, v103, v107
    v_mfma_f32_16x16x32_bf16 a[44:47], a[156:159], v[186:189], a[44:47]
    v_lshlrev_b32 v200, 16, v37
    v_alignbit_b32 v148, v108, v103, 16
    v_mfma_f32_16x16x32_bf16 a[48:51], a[112:115], v[154:157], a[48:51]
    buffer_load_dwordx4 v70, s[96:99], s62 offen offset:2048 lds
    v_mfma_f32_16x16x32_bf16 a[48:51], a[116:119], v[158:161], a[48:51]
    v_bfi_b32 v152, s55, v104, v108
    v_and_b32 v201, 0xffff0000, v37
    v_mfma_f32_16x16x32_bf16 a[48:51], a[120:123], v[162:165], a[48:51]
    ds_read_b128 a[88:91], v29 offset:4608
    v_bfi_b32 v121, s55, v109, v113
    v_mfma_f32_16x16x32_bf16 a[48:51], a[136:139], v[166:169], a[48:51]
    ds_read_b128 a[92:95], v28 offset:4608
    v_alignbit_b32 v125, v114, v109, 16
    v_mfma_f32_16x16x32_bf16 a[48:51], a[140:143], v[170:173], a[48:51]
    v_bfi_b32 v129, s55, v110, v114
    v_lshlrev_b32 v202, 16, v38
    v_mfma_f32_16x16x32_bf16 a[48:51], a[144:147], v[174:177], a[48:51]
    ds_read_b128 a[96:99], v28 offset:4624
    v_mfma_f32_16x16x32_bf16 a[48:51], a[160:163], v[178:181], a[48:51]
    buffer_load_dwordx4 v71, s[96:99], s62 offen offset:3072 lds
    v_mfma_f32_16x16x32_bf16 a[48:51], a[164:167], v[182:185], a[48:51]
    ds_read_b128 a[100:103], v28 offset:4848
    v_alignbit_b32 v133, v115, v110, 16
    v_mfma_f32_16x16x32_bf16 a[48:51], a[168:171], v[186:189], a[48:51]
    v_bfi_b32 v137, s55, v111, v115
    v_and_b32 v203, 0xffff0000, v38
    v_mfma_f32_16x16x32_bf16 a[52:55], a[124:127], v[154:157], a[52:55]
    ds_read_b128 a[104:107], v28 offset:4864
    v_alignbit_b32 v141, v116, v111, 16
    v_mfma_f32_16x16x32_bf16 a[52:55], a[128:131], v[158:161], a[52:55]
    ds_read_b128 a[108:111], v30 offset:4880
    s_add_u32 m0, s53, 8192
    v_mfma_f32_16x16x32_bf16 a[52:55], a[132:135], v[162:165], a[52:55]
    v_bfi_b32 v145, s55, v112, v116
    v_mfma_f32_16x16x32_bf16 a[52:55], a[148:151], v[166:169], a[52:55]
    buffer_load_dwordx4 v72, s[96:99], s62 offen offset:0 lds
    v_mfma_f32_16x16x32_bf16 a[52:55], a[152:155], v[170:173], a[52:55]
    v_lshlrev_b32 v204, 16, v39
    v_alignbit_b32 v149, v117, v112, 16
    v_mfma_f32_16x16x32_bf16 a[52:55], a[156:159], v[174:177], a[52:55]
    v_bfi_b32 v153, s55, v113, v117
    v_and_b32 v205, 0xffff0000, v39
    v_mfma_f32_16x16x32_bf16 a[52:55], a[172:175], v[178:181], a[52:55]
    s_add_u32 m0, s53, 20480
    v_mfma_f32_16x16x32_bf16 a[52:55], a[176:179], v[182:185], a[52:55]
    buffer_load_dwordx4 v20, s[28:31], s77 offen offset:0 lds
    v_mfma_f32_16x16x32_bf16 a[52:55], a[180:183], v[186:189], a[52:55]
    s_waitcnt vmcnt(13)
    ds_read_b128 v[82:85], v74 offset:10240
    v_mfma_f32_16x16x32_bf16 a[56:59], a[136:139], v[154:157], a[56:59]
    ds_read_b128 v[86:89], v75 offset:10240
    v_mfma_f32_16x16x32_bf16 a[56:59], a[140:143], v[158:161], a[56:59]
    ds_read_b128 a[112:115], v29 offset:8192
    v_mfma_f32_16x16x32_bf16 a[56:59], a[144:147], v[162:165], a[56:59]
    ds_read_b128 a[116:119], v28 offset:8192
    ds_read_b128 v[90:93], v76 offset:10240
    v_mfma_f32_16x16x32_bf16 a[56:59], a[160:163], v[166:169], a[56:59]
    buffer_load_dwordx4 v21, s[28:31], s77 offen offset:1024 lds
    v_mfma_f32_16x16x32_bf16 a[56:59], a[164:167], v[170:173], a[56:59]
    ds_read_b128 a[120:123], v28 offset:8208
    ds_read_b128 v[94:97], v77 offset:10240
    v_mfma_f32_16x16x32_bf16 a[56:59], a[168:171], v[174:177], a[56:59]
    ds_read_b128 a[124:127], v28 offset:8432
    v_mfma_f32_16x16x32_bf16 a[56:59], a[184:187], v[178:181], a[56:59]
    ds_read_b128 v[98:101], v74 offset:11264
    v_mfma_f32_16x16x32_bf16 a[56:59], a[188:191], v[182:185], a[56:59]
    ds_read_b128 a[128:131], v28 offset:8448
    v_mfma_f32_16x16x32_bf16 a[56:59], a[192:195], v[186:189], a[56:59]
    ds_read_b128 a[132:135], v30 offset:8464
    ds_read_b128 v[102:105], v75 offset:11264
    v_mfma_f32_16x16x32_bf16 a[60:63], a[148:151], v[154:157], a[60:63]
    buffer_load_dwordx4 v22, s[28:31], s77 offen offset:2048 lds
    v_mfma_f32_16x16x32_bf16 a[60:63], a[152:155], v[158:161], a[60:63]
    ds_read_b128 v[106:109], v76 offset:11264
    v_mfma_f32_16x16x32_bf16 a[60:63], a[156:159], v[162:165], a[60:63]
    v_mfma_f32_16x16x32_bf16 a[60:63], a[172:175], v[166:169], a[60:63]
    ds_read_b128 v[110:113], v77 offset:11264
    v_mfma_f32_16x16x32_bf16 a[60:63], a[176:179], v[170:173], a[60:63]
    buffer_load_dwordx4 v23, s[28:31], s77 offen offset:3072 lds
    v_mfma_f32_16x16x32_bf16 a[60:63], a[180:183], v[174:177], a[60:63]
    ds_read_b128 v[114:117], v74 offset:12288
    v_mfma_f32_16x16x32_bf16 a[60:63], a[196:199], v[178:181], a[60:63]
    v_mfma_f32_16x16x32_bf16 a[60:63], a[200:203], v[182:185], a[60:63]
    v_mfma_f32_16x16x32_bf16 a[60:63], a[204:207], v[186:189], a[60:63]
    s_waitcnt lgkmcnt(15)
    v_mfma_f32_16x16x32_bf16 a[0:3], a[64:67], v[118:121], a[0:3]
    s_add_u32 m0, s53, 24576
    v_mfma_f32_16x16x32_bf16 a[0:3], a[68:71], v[122:125], a[0:3]
    ds_read_b128 a[136:139], v29 offset:8704
    v_mfma_f32_16x16x32_bf16 a[0:3], a[72:75], v[126:129], a[0:3]
    s_waitcnt lgkmcnt(11)
    v_bfi_b32 v154, s55, v82, v86
    v_mfma_f32_16x16x32_bf16 a[0:3], a[88:91], v[130:133], a[0:3]
    buffer_load_dwordx4 v24, s[28:31], s77 offen offset:0 lds
    v_mfma_f32_16x16x32_bf16 a[0:3], a[92:95], v[134:137], a[0:3]
    ds_read_b128 a[140:143], v28 offset:8704
    v_alignbit_b32 v158, v87, v82, 16
    v_mfma_f32_16x16x32_bf16 a[0:3], a[96:99], v[138:141], a[0:3]
    v_bfi_b32 v162, s55, v83, v87
    s_waitcnt lgkmcnt(11)
    v_mfma_f32_16x16x32_bf16 a[0:3], a[112:115], v[142:145], a[0:3]
    ds_read_b128 a[144:147], v28 offset:8720
    ds_read_b128 a[148:151], v28 offset:8944
    v_mfma_f32_16x16x32_bf16 a[0:3], a[116:119], v[146:149], a[0:3]
    v_alignbit_b32 v166, v88, v83, 16
    v_mfma_f32_16x16x32_bf16 a[0:3], a[120:123], v[150:153], a[0:3]
    s_waitcnt lgkmcnt(4)
    s_add_u32 m0, s53, 10240
    v_mfma_f32_16x16x32_bf16 a[4:7], a[76:79], v[118:121], a[4:7]
    v_bfi_b32 v170, s55, v84, v88
    v_mfma_f32_16x16x32_bf16 a[4:7], a[80:83], v[122:125], a[4:7]
    buffer_load_dwordx4 v65, s[96:99], s63 offen offset:1024 lds
    v_mfma_f32_16x16x32_bf16 a[4:7], a[84:87], v[126:129], a[4:7]
    ds_read_b128 a[152:155], v28 offset:8960
    v_alignbit_b32 v174, v89, v84, 16
    v_mfma_f32_16x16x32_bf16 a[4:7], a[100:103], v[130:133], a[4:7]
    ds_read_b128 a[156:159], v30 offset:8976
    v_bfi_b32 v178, s55, v85, v89
    v_mfma_f32_16x16x32_bf16 a[4:7], a[104:107], v[134:137], a[4:7]
    v_alignbit_b32 v182, v90, v85, 16
    v_bfi_b32 v186, s55, v86, v90
    v_mfma_f32_16x16x32_bf16 a[4:7], a[108:111], v[138:141], a[4:7]
    buffer_load_dwordx4 v66, s[96:99], s63 offen offset:2048 lds
    v_mfma_f32_16x16x32_bf16 a[4:7], a[124:127], v[142:145], a[4:7]
    v_bfi_b32 v155, s55, v91, v95
    v_alignbit_b32 v159, v96, v91, 16
    v_mfma_f32_16x16x32_bf16 a[4:7], a[128:131], v[146:149], a[4:7]
    v_bfi_b32 v163, s55, v92, v96
    v_mfma_f32_16x16x32_bf16 a[4:7], a[132:135], v[150:153], a[4:7]
    v_alignbit_b32 v167, v97, v92, 16
    v_mfma_f32_16x16x32_bf16 a[8:11], a[88:91], v[118:121], a[8:11]
    buffer_load_dwordx4 v67, s[96:99], s63 offen offset:3072 lds
    v_mfma_f32_16x16x32_bf16 a[8:11], a[92:95], v[122:125], a[8:11]
    v_bfi_b32 v171, s55, v93, v97
    v_alignbit_b32 v175, v98, v93, 16
    v_mfma_f32_16x16x32_bf16 a[8:11], a[96:99], v[126:129], a[8:11]
    v_mfma_f32_16x16x32_bf16 a[8:11], a[112:115], v[130:133], a[8:11]
    v_bfi_b32 v179, s55, v94, v98
    v_mfma_f32_16x16x32_bf16 a[8:11], a[116:119], v[134:137], a[8:11]
    v_alignbit_b32 v183, v99, v94, 16
    s_add_u32 m0, s53, 14336
    v_mfma_f32_16x16x32_bf16 a[8:11], a[120:123], v[138:141], a[8:11]
    ds_read_b128 a[160:163], v29 offset:12288
    s_waitcnt lgkmcnt(4)
    v_mfma_f32_16x16x32_bf16 a[8:11], a[136:139], v[142:145], a[8:11]
    v_bfi_b32 v187, s55, v95, v99
    v_mfma_f32_16x16x32_bf16 a[8:11], a[140:143], v[146:149], a[8:11]
    buffer_load_dwordx4 v68, s[96:99], s63 offen offset:0 lds
    v_mfma_f32_16x16x32_bf16 a[8:11], a[144:147], v[150:153], a[8:11]
    ds_read_b128 a[164:167], v28 offset:12288
    v_bfi_b32 v156, s55, v100, v104
    v_mfma_f32_16x16x32_bf16 a[12:15], a[100:103], v[118:121], a[12:15]
    ds_read_b128 a[168:171], v28 offset:12304
    v_alignbit_b32 v160, v105, v100, 16
    v_mfma_f32_16x16x32_bf16 a[12:15], a[104:107], v[122:125], a[12:15]
    ds_read_b128 a[172:175], v28 offset:12528
    v_bfi_b32 v164, s55, v101, v105
    v_mfma_f32_16x16x32_bf16 a[12:15], a[108:111], v[126:129], a[12:15]
    buffer_load_dwordx4 v69, s[96:99], s63 offen offset:1024 lds
    v_mfma_f32_16x16x32_bf16 a[12:15], a[124:127], v[130:133], a[12:15]
    ds_read_b128 a[176:179], v28 offset:12544
    v_alignbit_b32 v168, v106, v101, 16
    v_mfma_f32_16x16x32_bf16 a[12:15], a[128:131], v[134:137], a[12:15]
    ds_read_b128 a[180:183], v30 offset:12560
    v_bfi_b32 v172, s55, v102, v106
    v_mfma_f32_16x16x32_bf16 a[12:15], a[132:135], v[138:141], a[12:15]
    v_alignbit_b32 v176, v107, v102, 16
    s_waitcnt lgkmcnt(6)
    v_mfma_f32_16x16x32_bf16 a[12:15], a[148:151], v[142:145], a[12:15]
    v_bfi_b32 v180, s55, v103, v107
    v_mfma_f32_16x16x32_bf16 a[12:15], a[152:155], v[146:149], a[12:15]
    v_alignbit_b32 v184, v108, v103, 16
    v_mfma_f32_16x16x32_bf16 a[12:15], a[156:159], v[150:153], a[12:15]
    buffer_load_dwordx4 v70, s[96:99], s63 offen offset:2048 lds
    v_mfma_f32_16x16x32_bf16 a[16:19], a[112:115], v[118:121], a[16:19]
    v_bfi_b32 v188, s55, v104, v108
    v_mfma_f32_16x16x32_bf16 a[16:19], a[116:119], v[122:125], a[16:19]
    v_bfi_b32 v157, s55, v109, v113
    v_mfma_f32_16x16x32_bf16 a[16:19], a[120:123], v[126:129], a[16:19]
    v_alignbit_b32 v161, v114, v109, 16
    v_mfma_f32_16x16x32_bf16 a[16:19], a[136:139], v[130:133], a[16:19]
    v_bfi_b32 v165, s55, v110, v114
    v_mfma_f32_16x16x32_bf16 a[16:19], a[140:143], v[134:137], a[16:19]
    buffer_load_dwordx4 v71, s[96:99], s63 offen offset:3072 lds
    v_mfma_f32_16x16x32_bf16 a[16:19], a[144:147], v[138:141], a[16:19]
    ds_read_b128 a[184:187], v29 offset:12800
    s_waitcnt lgkmcnt(4)
    v_mfma_f32_16x16x32_bf16 a[16:19], a[160:163], v[142:145], a[16:19]
    v_alignbit_b32 v169, v115, v110, 16
    ds_read_b128 a[188:191], v28 offset:12800
    v_mfma_f32_16x16x32_bf16 a[16:19], a[164:167], v[146:149], a[16:19]
    v_bfi_b32 v173, s55, v111, v115
    v_alignbit_b32 v177, v116, v111, 16
    v_mfma_f32_16x16x32_bf16 a[16:19], a[168:171], v[150:153], a[16:19]
    ds_read_b128 a[192:195], v28 offset:12816
    s_add_u32 m0, s53, 18432
    v_mfma_f32_16x16x32_bf16 a[20:23], a[124:127], v[118:121], a[20:23]
    ds_read_b128 a[196:199], v28 offset:13040
    v_bfi_b32 v181, s55, v112, v116
    v_mfma_f32_16x16x32_bf16 a[20:23], a[128:131], v[122:125], a[20:23]
    buffer_load_dwordx4 v72, s[96:99], s63 offen offset:0 lds
    v_mfma_f32_16x16x32_bf16 a[20:23], a[132:135], v[126:129], a[20:23]
    v_alignbit_b32 v185, v117, v112, 16
    ds_read_b128 a[200:203], v28 offset:13056
    v_mfma_f32_16x16x32_bf16 a[20:23], a[148:151], v[130:133], a[20:23]
    v_bfi_b32 v189, s55, v113, v117
    ds_read_b128 a[204:207], v30 offset:13072
    v_mfma_f32_16x16x32_bf16 a[20:23], a[152:155], v[134:137], a[20:23]
    s_add_u32 m0, s53, 24576
    v_mfma_f32_16x16x32_bf16 a[20:23], a[156:159], v[138:141], a[20:23]
    s_waitcnt lgkmcnt(6)
    v_mfma_f32_16x16x32_bf16 a[20:23], a[172:175], v[142:145], a[20:23]
    buffer_load_dwordx4 v25, s[28:31], s77 offen offset:1024 lds
    v_mfma_f32_16x16x32_bf16 a[20:23], a[176:179], v[146:149], a[20:23]
    s_waitcnt vmcnt(14)
    ds_read_b128 v[82:85], v78 offset:0
    v_mfma_f32_16x16x32_bf16 a[20:23], a[180:183], v[150:153], a[20:23]
    v_mfma_f32_16x16x32_bf16 a[24:27], a[136:139], v[118:121], a[24:27]
    ds_read_b128 v[86:89], v79 offset:0
    v_mfma_f32_16x16x32_bf16 a[24:27], a[140:143], v[122:125], a[24:27]
    v_mfma_f32_16x16x32_bf16 a[24:27], a[144:147], v[126:129], a[24:27]
    ds_read_b128 v[90:93], v80 offset:0
    v_mfma_f32_16x16x32_bf16 a[24:27], a[160:163], v[130:133], a[24:27]
    buffer_load_dwordx4 v26, s[28:31], s77 offen offset:2048 lds
    v_mfma_f32_16x16x32_bf16 a[24:27], a[164:167], v[134:137], a[24:27]
    ds_read_b128 v[94:97], v81 offset:0
    v_mfma_f32_16x16x32_bf16 a[24:27], a[168:171], v[138:141], a[24:27]
    s_waitcnt lgkmcnt(7)
    v_mfma_f32_16x16x32_bf16 a[24:27], a[184:187], v[142:145], a[24:27]
    ds_read_b128 v[98:101], v74 offset:1024
    v_mfma_f32_16x16x32_bf16 a[24:27], a[188:191], v[146:149], a[24:27]
    buffer_load_dwordx4 v27, s[28:31], s77 offen offset:3072 lds
    v_mfma_f32_16x16x32_bf16 a[24:27], a[192:195], v[150:153], a[24:27]
    ds_read_b128 v[102:105], v75 offset:1024
    v_mfma_f32_16x16x32_bf16 a[28:31], a[148:151], v[118:121], a[28:31]
    v_mfma_f32_16x16x32_bf16 a[28:31], a[152:155], v[122:125], a[28:31]
    ds_read_b128 v[106:109], v76 offset:1024
    v_mfma_f32_16x16x32_bf16 a[28:31], a[156:159], v[126:129], a[28:31]
    v_mfma_f32_16x16x32_bf16 a[28:31], a[172:175], v[130:133], a[28:31]
    ds_read_b128 v[110:113], v77 offset:1024
    v_mfma_f32_16x16x32_bf16 a[28:31], a[176:179], v[134:137], a[28:31]
    v_mfma_f32_16x16x32_bf16 a[28:31], a[180:183], v[138:141], a[28:31]
    ds_read_b128 v[114:117], v74 offset:2048
    s_waitcnt lgkmcnt(9)
    v_mfma_f32_16x16x32_bf16 a[28:31], a[196:199], v[142:145], a[28:31]
    v_mfma_f32_16x16x32_bf16 a[28:31], a[200:203], v[146:149], a[28:31]
    v_mfma_f32_16x16x32_bf16 a[28:31], a[204:207], v[150:153], a[28:31]
    v_mfma_f32_16x16x32_bf16 a[32:35], a[64:67], v[154:157], a[32:35]
    v_mfma_f32_16x16x32_bf16 a[32:35], a[68:71], v[158:161], a[32:35]
    s_waitcnt lgkmcnt(6)
    v_bfi_b32 v118, s55, v82, v86
    v_mfma_f32_16x16x32_bf16 a[32:35], a[72:75], v[162:165], a[32:35]
    v_alignbit_b32 v122, v87, v82, 16
    v_mfma_f32_16x16x32_bf16 a[32:35], a[88:91], v[166:169], a[32:35]
    v_bfi_b32 v126, s55, v83, v87
    v_mfma_f32_16x16x32_bf16 a[32:35], a[92:95], v[170:173], a[32:35]
    v_mfma_f32_16x16x32_bf16 a[32:35], a[96:99], v[174:177], a[32:35]
    v_alignbit_b32 v130, v88, v83, 16
    v_mfma_f32_16x16x32_bf16 a[32:35], a[112:115], v[178:181], a[32:35]
    v_bfi_b32 v134, s55, v84, v88
    v_mfma_f32_16x16x32_bf16 a[32:35], a[116:119], v[182:185], a[32:35]
    v_alignbit_b32 v138, v89, v84, 16
    v_mfma_f32_16x16x32_bf16 a[32:35], a[120:123], v[186:189], a[32:35]
    v_mfma_f32_16x16x32_bf16 a[36:39], a[76:79], v[154:157], a[36:39]
    v_bfi_b32 v142, s55, v85, v89
    v_mfma_f32_16x16x32_bf16 a[36:39], a[80:83], v[158:161], a[36:39]
    v_alignbit_b32 v146, v90, v85, 16
    v_mfma_f32_16x16x32_bf16 a[36:39], a[84:87], v[162:165], a[36:39]
    v_bfi_b32 v150, s55, v86, v90
    v_mfma_f32_16x16x32_bf16 a[36:39], a[100:103], v[166:169], a[36:39]
    v_mfma_f32_16x16x32_bf16 a[36:39], a[104:107], v[170:173], a[36:39]
    s_waitcnt lgkmcnt(4)
    v_bfi_b32 v119, s55, v91, v95
    v_mfma_f32_16x16x32_bf16 a[36:39], a[108:111], v[174:177], a[36:39]
    v_alignbit_b32 v123, v96, v91, 16
    v_mfma_f32_16x16x32_bf16 a[36:39], a[124:127], v[178:181], a[36:39]
    v_bfi_b32 v127, s55, v92, v96
    v_mfma_f32_16x16x32_bf16 a[36:39], a[128:131], v[182:185], a[36:39]
    v_mfma_f32_16x16x32_bf16 a[36:39], a[132:135], v[186:189], a[36:39]
    v_alignbit_b32 v131, v97, v92, 16
    v_mfma_f32_16x16x32_bf16 a[40:43], a[88:91], v[154:157], a[40:43]
    v_bfi_b32 v135, s55, v93, v97
    v_mfma_f32_16x16x32_bf16 a[40:43], a[92:95], v[158:161], a[40:43]
    ds_read_b128 a[64:67], v29 offset:16384
    v_alignbit_b32 v139, v98, v93, 16
    v_mfma_f32_16x16x32_bf16 a[40:43], a[96:99], v[162:165], a[40:43]
    ds_read_b128 a[68:71], v28 offset:16384
    v_mfma_f32_16x16x32_bf16 a[40:43], a[112:115], v[166:169], a[40:43]
    v_bfi_b32 v143, s55, v94, v98
    v_mfma_f32_16x16x32_bf16 a[40:43], a[116:119], v[170:173], a[40:43]
    ds_read_b128 a[72:75], v28 offset:16400
    v_alignbit_b32 v147, v99, v94, 16
    v_mfma_f32_16x16x32_bf16 a[40:43], a[120:123], v[174:177], a[40:43]
    ds_read_b128 a[76:79], v28 offset:16624
    v_bfi_b32 v151, s55, v95, v99
    v_mfma_f32_16x16x32_bf16 a[40:43], a[136:139], v[178:181], a[40:43]
    v_mfma_f32_16x16x32_bf16 a[40:43], a[140:143], v[182:185], a[40:43]
    ds_read_b128 a[80:83], v28 offset:16640
    v_mfma_f32_16x16x32_bf16 a[40:43], a[144:147], v[186:189], a[40:43]
    s_waitcnt lgkmcnt(7)
    v_bfi_b32 v120, s55, v100, v104
    v_mfma_f32_16x16x32_bf16 a[44:47], a[100:103], v[154:157], a[44:47]
    ds_read_b128 a[84:87], v30 offset:16656
    v_alignbit_b32 v124, v105, v100, 16
    v_mfma_f32_16x16x32_bf16 a[44:47], a[104:107], v[158:161], a[44:47]
    v_bfi_b32 v128, s55, v101, v105
    v_mfma_f32_16x16x32_bf16 a[44:47], a[108:111], v[162:165], a[44:47]
    v_alignbit_b32 v132, v106, v101, 16
    v_mfma_f32_16x16x32_bf16 a[44:47], a[124:127], v[166:169], a[44:47]
    v_bfi_b32 v136, s55, v102, v106
    v_mfma_f32_16x16x32_bf16 a[44:47], a[128:131], v[170:173], a[44:47]
    v_alignbit_b32 v140, v107, v102, 16
    v_mfma_f32_16x16x32_bf16 a[44:47], a[132:135], v[174:177], a[44:47]
    v_mfma_f32_16x16x32_bf16 a[44:47], a[148:151], v[178:181], a[44:47]
    v_bfi_b32 v144, s55, v103, v107
    v_mfma_f32_16x16x32_bf16 a[44:47], a[152:155], v[182:185], a[44:47]
    v_alignbit_b32 v148, v108, v103, 16
    v_mfma_f32_16x16x32_bf16 a[44:47], a[156:159], v[186:189], a[44:47]
    v_bfi_b32 v152, s55, v104, v108
    v_mfma_f32_16x16x32_bf16 a[48:51], a[112:115], v[154:157], a[48:51]
    v_mfma_f32_16x16x32_bf16 a[48:51], a[116:119], v[158:161], a[48:51]
    ds_read_b128 a[88:91], v29 offset:16896
    v_mfma_f32_16x16x32_bf16 a[48:51], a[120:123], v[162:165], a[48:51]
    s_waitcnt lgkmcnt(7)
    v_bfi_b32 v121, s55, v109, v113
    v_mfma_f32_16x16x32_bf16 a[48:51], a[136:139], v[166:169], a[48:51]
    ds_read_b128 a[92:95], v28 offset:16896
    v_alignbit_b32 v125, v114, v109, 16
    v_mfma_f32_16x16x32_bf16 a[48:51], a[140:143], v[170:173], a[48:51]
    v_bfi_b32 v129, s55, v110, v114
    ds_read_b128 a[96:99], v28 offset:16912
    v_mfma_f32_16x16x32_bf16 a[48:51], a[144:147], v[174:177], a[48:51]
    ds_read_b128 a[100:103], v28 offset:17136
    v_alignbit_b32 v133, v115, v110, 16
    v_mfma_f32_16x16x32_bf16 a[48:51], a[160:163], v[178:181], a[48:51]
    v_bfi_b32 v137, s55, v111, v115
    v_mfma_f32_16x16x32_bf16 a[48:51], a[164:167], v[182:185], a[48:51]
    ds_read_b128 a[104:107], v28 offset:17152
    v_alignbit_b32 v141, v116, v111, 16
    v_mfma_f32_16x16x32_bf16 a[48:51], a[168:171], v[186:189], a[48:51]
    ds_read_b128 a[108:111], v30 offset:17168
    v_mfma_f32_16x16x32_bf16 a[52:55], a[124:127], v[154:157], a[52:55]
    v_bfi_b32 v145, s55, v112, v116
    v_mfma_f32_16x16x32_bf16 a[52:55], a[128:131], v[158:161], a[52:55]
    v_alignbit_b32 v149, v117, v112, 16
    v_mfma_f32_16x16x32_bf16 a[52:55], a[132:135], v[162:165], a[52:55]
    v_bfi_b32 v153, s55, v113, v117
    v_mfma_f32_16x16x32_bf16 a[52:55], a[148:151], v[166:169], a[52:55]
    v_mfma_f32_16x16x32_bf16 a[52:55], a[152:155], v[170:173], a[52:55]
    v_mfma_f32_16x16x32_bf16 a[52:55], a[156:159], v[174:177], a[52:55]
    v_mfma_f32_16x16x32_bf16 a[52:55], a[172:175], v[178:181], a[52:55]
    v_mfma_f32_16x16x32_bf16 a[52:55], a[176:179], v[182:185], a[52:55]
    s_waitcnt vmcnt(3)
    ds_read_b128 v[82:85], v78 offset:10240
    v_mfma_f32_16x16x32_bf16 a[52:55], a[180:183], v[186:189], a[52:55]
    v_mfma_f32_16x16x32_bf16 a[56:59], a[136:139], v[154:157], a[56:59]
    ds_read_b128 v[86:89], v79 offset:10240
    v_mfma_f32_16x16x32_bf16 a[56:59], a[140:143], v[158:161], a[56:59]
    ds_read_b128 a[112:115], v29 offset:0
    v_mfma_f32_16x16x32_bf16 a[56:59], a[144:147], v[162:165], a[56:59]
    ds_read_b128 a[116:119], v28 offset:0
    ds_read_b128 v[90:93], v80 offset:10240
    v_mfma_f32_16x16x32_bf16 a[56:59], a[160:163], v[166:169], a[56:59]
    v_mfma_f32_16x16x32_bf16 a[56:59], a[164:167], v[170:173], a[56:59]
    ds_read_b128 a[120:123], v28 offset:16
    ds_read_b128 v[94:97], v81 offset:10240
    v_mfma_f32_16x16x32_bf16 a[56:59], a[168:171], v[174:177], a[56:59]
    ds_read_b128 a[124:127], v28 offset:240
    v_mfma_f32_16x16x32_bf16 a[56:59], a[184:187], v[178:181], a[56:59]
    ds_read_b128 v[98:101], v74 offset:11264
    v_mfma_f32_16x16x32_bf16 a[56:59], a[188:191], v[182:185], a[56:59]
    ds_read_b128 a[128:131], v28 offset:256
    v_mfma_f32_16x16x32_bf16 a[56:59], a[192:195], v[186:189], a[56:59]
    ds_read_b128 a[132:135], v30 offset:272
    ds_read_b128 v[102:105], v75 offset:11264
    v_mfma_f32_16x16x32_bf16 a[60:63], a[148:151], v[154:157], a[60:63]
    v_mfma_f32_16x16x32_bf16 a[60:63], a[152:155], v[158:161], a[60:63]
    ds_read_b128 v[106:109], v76 offset:11264
    v_mfma_f32_16x16x32_bf16 a[60:63], a[156:159], v[162:165], a[60:63]
    v_mfma_f32_16x16x32_bf16 a[60:63], a[172:175], v[166:169], a[60:63]
    ds_read_b128 v[110:113], v77 offset:11264
    v_mfma_f32_16x16x32_bf16 a[60:63], a[176:179], v[170:173], a[60:63]
    v_mfma_f32_16x16x32_bf16 a[60:63], a[180:183], v[174:177], a[60:63]
    ds_read_b128 v[114:117], v74 offset:12288
    v_mfma_f32_16x16x32_bf16 a[60:63], a[196:199], v[178:181], a[60:63]
    v_mfma_f32_16x16x32_bf16 a[60:63], a[200:203], v[182:185], a[60:63]
    v_mfma_f32_16x16x32_bf16 a[60:63], a[204:207], v[186:189], a[60:63]
    s_waitcnt lgkmcnt(15)
    v_mfma_f32_16x16x32_bf16 a[0:3], a[64:67], v[118:121], a[0:3]
    s_lshl_b32 s68, s44, 11
    s_add_u32 s68, s68, 20480
    v_mfma_f32_16x16x32_bf16 a[0:3], a[68:71], v[122:125], a[0:3]
    ds_read_b128 a[136:139], v29 offset:512
    v_mfma_f32_16x16x32_bf16 a[0:3], a[72:75], v[126:129], a[0:3]
    s_waitcnt lgkmcnt(11)
    v_bfi_b32 v154, s55, v82, v86
    v_mfma_f32_16x16x32_bf16 a[0:3], a[88:91], v[130:133], a[0:3]
    ds_read_b128 a[140:143], v28 offset:512
    v_alignbit_b32 v158, v87, v82, 16
    v_mfma_f32_16x16x32_bf16 a[0:3], a[92:95], v[134:137], a[0:3]
    v_add_u32 v52, s68, v31
    v_add_u32 v53, 81920, v52
    v_mfma_f32_16x16x32_bf16 a[0:3], a[96:99], v[138:141], a[0:3]
    v_bfi_b32 v162, s55, v83, v87
    s_waitcnt lgkmcnt(11)
    v_mfma_f32_16x16x32_bf16 a[0:3], a[112:115], v[142:145], a[0:3]
    ds_read_b128 a[144:147], v28 offset:528
    ds_read_b128 a[148:151], v28 offset:752
    v_mfma_f32_16x16x32_bf16 a[0:3], a[116:119], v[146:149], a[0:3]
    v_alignbit_b32 v166, v88, v83, 16
    v_bfi_b32 v170, s55, v84, v88
    v_mfma_f32_16x16x32_bf16 a[0:3], a[120:123], v[150:153], a[0:3]
    ds_read_b128 a[152:155], v28 offset:768
    v_alignbit_b32 v174, v89, v84, 16
    v_mfma_f32_16x16x32_bf16 a[4:7], a[76:79], v[118:121], a[4:7]
    ds_read_b128 a[156:159], v30 offset:784
    v_bfi_b32 v178, s55, v85, v89
    v_mfma_f32_16x16x32_bf16 a[4:7], a[80:83], v[122:125], a[4:7]
    v_alignbit_b32 v182, v90, v85, 16
    v_mfma_f32_16x16x32_bf16 a[4:7], a[84:87], v[126:129], a[4:7]
    v_bfi_b32 v186, s55, v86, v90
    v_mfma_f32_16x16x32_bf16 a[4:7], a[100:103], v[130:133], a[4:7]
    v_mfma_f32_16x16x32_bf16 a[4:7], a[104:107], v[134:137], a[4:7]
    s_waitcnt lgkmcnt(12)
    v_bfi_b32 v155, s55, v91, v95
    v_mfma_f32_16x16x32_bf16 a[4:7], a[108:111], v[138:141], a[4:7]
    v_alignbit_b32 v159, v96, v91, 16
    s_waitcnt lgkmcnt(10)
    v_mfma_f32_16x16x32_bf16 a[4:7], a[124:127], v[142:145], a[4:7]
    v_bfi_b32 v163, s55, v92, v96
    v_mfma_f32_16x16x32_bf16 a[4:7], a[128:131], v[146:149], a[4:7]
    v_mfma_f32_16x16x32_bf16 a[4:7], a[132:135], v[150:153], a[4:7]
    v_alignbit_b32 v167, v97, v92, 16
    v_mfma_f32_16x16x32_bf16 a[8:11], a[88:91], v[118:121], a[8:11]
    ds_write_b128 v51, a[0:3] offset:8192
    v_mfma_f32_16x16x32_bf16 a[8:11], a[92:95], v[122:125], a[8:11]
    v_bfi_b32 v171, s55, v93, v97
    v_alignbit_b32 v175, v98, v93, 16
    v_mfma_f32_16x16x32_bf16 a[8:11], a[96:99], v[126:129], a[8:11]
    v_mfma_f32_16x16x32_bf16 a[8:11], a[112:115], v[130:133], a[8:11]
    v_bfi_b32 v179, s55, v94, v98
    v_mfma_f32_16x16x32_bf16 a[8:11], a[116:119], v[134:137], a[8:11]
    v_alignbit_b32 v183, v99, v94, 16
    v_mfma_f32_16x16x32_bf16 a[8:11], a[120:123], v[138:141], a[8:11]
    s_waitcnt lgkmcnt(4)
    v_mfma_f32_16x16x32_bf16 a[8:11], a[136:139], v[142:145], a[8:11]
    s_waitcnt vmcnt(0)
    ds_read_b128 a[160:163], v29 offset:4096
    v_mfma_f32_16x16x32_bf16 a[8:11], a[140:143], v[146:149], a[8:11]
    v_bfi_b32 v187, s55, v95, v99
    ds_read_b128 a[164:167], v28 offset:4096
    v_mfma_f32_16x16x32_bf16 a[8:11], a[144:147], v[150:153], a[8:11]
    v_bfi_b32 v156, s55, v100, v104
    ds_read_b128 a[168:171], v28 offset:4112
    v_mfma_f32_16x16x32_bf16 a[12:15], a[100:103], v[118:121], a[12:15]
    v_alignbit_b32 v160, v105, v100, 16
    v_mfma_f32_16x16x32_bf16 a[12:15], a[104:107], v[122:125], a[12:15]
    ds_write_b128 v51, a[4:7] offset:9216
    v_mfma_f32_16x16x32_bf16 a[12:15], a[108:111], v[126:129], a[12:15]
    ds_read_b128 a[172:175], v28 offset:4336
    v_bfi_b32 v164, s55, v101, v105
    v_mfma_f32_16x16x32_bf16 a[12:15], a[124:127], v[130:133], a[12:15]
    ds_read_b128 a[176:179], v28 offset:4352
    v_alignbit_b32 v168, v106, v101, 16
    v_mfma_f32_16x16x32_bf16 a[12:15], a[128:131], v[134:137], a[12:15]
    ds_read_b128 a[180:183], v30 offset:4368
    v_bfi_b32 v172, s55, v102, v106
    v_mfma_f32_16x16x32_bf16 a[12:15], a[132:135], v[138:141], a[12:15]
    v_alignbit_b32 v176, v107, v102, 16
    s_waitcnt lgkmcnt(8)
    v_mfma_f32_16x16x32_bf16 a[12:15], a[148:151], v[142:145], a[12:15]
    v_bfi_b32 v180, s55, v103, v107
    v_mfma_f32_16x16x32_bf16 a[12:15], a[152:155], v[146:149], a[12:15]
    v_alignbit_b32 v184, v108, v103, 16
    v_mfma_f32_16x16x32_bf16 a[12:15], a[156:159], v[150:153], a[12:15]
    v_bfi_b32 v188, s55, v104, v108
    v_mfma_f32_16x16x32_bf16 a[16:19], a[112:115], v[118:121], a[16:19]
    ds_write_b128 v51, a[8:11] offset:10240
    v_mfma_f32_16x16x32_bf16 a[16:19], a[116:119], v[122:125], a[16:19]
    v_bfi_b32 v157, s55, v109, v113
    v_mfma_f32_16x16x32_bf16 a[16:19], a[120:123], v[126:129], a[16:19]
    v_alignbit_b32 v161, v114, v109, 16
    v_mfma_f32_16x16x32_bf16 a[16:19], a[136:139], v[130:133], a[16:19]
    v_bfi_b32 v165, s55, v110, v114
    v_mfma_f32_16x16x32_bf16 a[16:19], a[140:143], v[134:137], a[16:19]
    v_mfma_f32_16x16x32_bf16 a[16:19], a[144:147], v[138:141], a[16:19]
    ds_read_b128 a[184:187], v29 offset:4608
    s_waitcnt lgkmcnt(6)
    v_mfma_f32_16x16x32_bf16 a[16:19], a[160:163], v[142:145], a[16:19]
    v_alignbit_b32 v169, v115, v110, 16
    ds_read_b128 a[188:191], v28 offset:4608
    v_mfma_f32_16x16x32_bf16 a[16:19], a[164:167], v[146:149], a[16:19]
    v_bfi_b32 v173, s55, v111, v115
    v_alignbit_b32 v177, v116, v111, 16
    v_mfma_f32_16x16x32_bf16 a[16:19], a[168:171], v[150:153], a[16:19]
    ds_read_b128 a[192:195], v28 offset:4624
    v_mfma_f32_16x16x32_bf16 a[20:23], a[124:127], v[118:121], a[20:23]
    ds_write_b128 v51, a[12:15] offset:11264
    v_mfma_f32_16x16x32_bf16 a[20:23], a[128:131], v[122:125], a[20:23]
    ds_read_b128 a[196:199], v28 offset:4848
    v_bfi_b32 v181, s55, v112, v116
    v_mfma_f32_16x16x32_bf16 a[20:23], a[132:135], v[126:129], a[20:23]
    v_alignbit_b32 v185, v117, v112, 16
    ds_read_b128 a[200:203], v28 offset:4864
    v_mfma_f32_16x16x32_bf16 a[20:23], a[148:151], v[130:133], a[20:23]
    v_bfi_b32 v189, s55, v113, v117
    ds_read_b128 a[204:207], v30 offset:4880
    v_mfma_f32_16x16x32_bf16 a[20:23], a[152:155], v[134:137], a[20:23]
    v_mfma_f32_16x16x32_bf16 a[20:23], a[156:159], v[138:141], a[20:23]
    s_waitcnt lgkmcnt(8)
    v_mfma_f32_16x16x32_bf16 a[20:23], a[172:175], v[142:145], a[20:23]
    v_mfma_f32_16x16x32_bf16 a[20:23], a[176:179], v[146:149], a[20:23]
    v_mfma_f32_16x16x32_bf16 a[20:23], a[180:183], v[150:153], a[20:23]
    ds_write_b128 v51, a[16:19] offset:12288
    v_mfma_f32_16x16x32_bf16 a[24:27], a[136:139], v[118:121], a[24:27]
    v_mfma_f32_16x16x32_bf16 a[24:27], a[140:143], v[122:125], a[24:27]
    v_mfma_f32_16x16x32_bf16 a[24:27], a[144:147], v[126:129], a[24:27]
    v_mfma_f32_16x16x32_bf16 a[24:27], a[160:163], v[130:133], a[24:27]
    v_mfma_f32_16x16x32_bf16 a[24:27], a[164:167], v[134:137], a[24:27]
    v_mfma_f32_16x16x32_bf16 a[24:27], a[168:171], v[138:141], a[24:27]
    s_waitcnt lgkmcnt(5)
    v_mfma_f32_16x16x32_bf16 a[24:27], a[184:187], v[142:145], a[24:27]
    v_mfma_f32_16x16x32_bf16 a[24:27], a[188:191], v[146:149], a[24:27]
    v_mfma_f32_16x16x32_bf16 a[24:27], a[192:195], v[150:153], a[24:27]
    ds_write_b128 v51, a[20:23] offset:13312
    v_mfma_f32_16x16x32_bf16 a[28:31], a[148:151], v[118:121], a[28:31]
    v_mfma_f32_16x16x32_bf16 a[28:31], a[152:155], v[122:125], a[28:31]
    v_mfma_f32_16x16x32_bf16 a[28:31], a[156:159], v[126:129], a[28:31]
    v_mfma_f32_16x16x32_bf16 a[28:31], a[172:175], v[130:133], a[28:31]
    v_mfma_f32_16x16x32_bf16 a[28:31], a[176:179], v[134:137], a[28:31]
    v_mfma_f32_16x16x32_bf16 a[28:31], a[180:183], v[138:141], a[28:31]
    s_waitcnt lgkmcnt(2)
    v_mfma_f32_16x16x32_bf16 a[28:31], a[196:199], v[142:145], a[28:31]
    v_mfma_f32_16x16x32_bf16 a[28:31], a[200:203], v[146:149], a[28:31]
    v_mfma_f32_16x16x32_bf16 a[28:31], a[204:207], v[150:153], a[28:31]
    ds_write_b128 v51, a[24:27] offset:14336
    v_mfma_f32_16x16x32_bf16 a[32:35], a[64:67], v[154:157], a[32:35]
    v_mfma_f32_16x16x32_bf16 a[32:35], a[68:71], v[158:161], a[32:35]
    v_mfma_f32_16x16x32_bf16 a[32:35], a[72:75], v[162:165], a[32:35]
    v_mfma_f32_16x16x32_bf16 a[32:35], a[88:91], v[166:169], a[32:35]
    v_mfma_f32_16x16x32_bf16 a[32:35], a[92:95], v[170:173], a[32:35]
    v_mfma_f32_16x16x32_bf16 a[32:35], a[96:99], v[174:177], a[32:35]
    v_mfma_f32_16x16x32_bf16 a[32:35], a[112:115], v[178:181], a[32:35]
    v_mfma_f32_16x16x32_bf16 a[32:35], a[116:119], v[182:185], a[32:35]
    v_mfma_f32_16x16x32_bf16 a[32:35], a[120:123], v[186:189], a[32:35]
    ds_write_b128 v51, a[28:31] offset:15360
    v_mfma_f32_16x16x32_bf16 a[36:39], a[76:79], v[154:157], a[36:39]
    v_mfma_f32_16x16x32_bf16 a[36:39], a[80:83], v[158:161], a[36:39]
    v_mfma_f32_16x16x32_bf16 a[36:39], a[84:87], v[162:165], a[36:39]
    v_mfma_f32_16x16x32_bf16 a[36:39], a[100:103], v[166:169], a[36:39]
    v_mfma_f32_16x16x32_bf16 a[36:39], a[104:107], v[170:173], a[36:39]
    v_mfma_f32_16x16x32_bf16 a[36:39], a[108:111], v[174:177], a[36:39]
    s_waitcnt lgkmcnt(0)
    s_barrier
    v_mfma_f32_16x16x32_bf16 a[36:39], a[124:127], v[178:181], a[36:39]
    ds_read_b128 v[216:219], v52 offset:8192
    v_mfma_f32_16x16x32_bf16 a[36:39], a[128:131], v[182:185], a[36:39]
    ds_read_b128 v[232:235], v52 offset:49152
    v_mfma_f32_16x16x32_bf16 a[36:39], a[132:135], v[186:189], a[36:39]
    ds_write_b128 v51, a[32:35] offset:0
    v_mfma_f32_16x16x32_bf16 a[40:43], a[88:91], v[154:157], a[40:43]
    ds_read_b128 v[236:239], v53 offset:8192
    ds_read_b128 v[240:243], v53 offset:49152
    v_mfma_f32_16x16x32_bf16 a[40:43], a[92:95], v[158:161], a[40:43]
    ds_read_b128 v[220:223], v52 offset:9216
    v_mfma_f32_16x16x32_bf16 a[40:43], a[96:99], v[162:165], a[40:43]
    ds_read_b128 v[244:247], v52 offset:50176
    v_mfma_f32_16x16x32_bf16 a[40:43], a[112:115], v[166:169], a[40:43]
    ds_read_b128 v[248:251], v53 offset:9216
    v_mfma_f32_16x16x32_bf16 a[40:43], a[116:119], v[170:173], a[40:43]
    ds_read_b128 v[252:255], v53 offset:50176
    v_mfma_f32_16x16x32_bf16 a[40:43], a[120:123], v[174:177], a[40:43]
    v_mfma_f32_16x16x32_bf16 a[40:43], a[136:139], v[178:181], a[40:43]
    v_mfma_f32_16x16x32_bf16 a[40:43], a[140:143], v[182:185], a[40:43]
    v_mfma_f32_16x16x32_bf16 a[40:43], a[144:147], v[186:189], a[40:43]
    ds_write_b128 v51, a[36:39] offset:1024
    v_mfma_f32_16x16x32_bf16 a[44:47], a[100:103], v[154:157], a[44:47]
    s_waitcnt lgkmcnt(5)
    v_add_f32 v216, v216, v232
    v_mfma_f32_16x16x32_bf16 a[44:47], a[104:107], v[158:161], a[44:47]
    v_add_f32 v217, v217, v233
    v_add_f32 v218, v218, v234
    v_mfma_f32_16x16x32_bf16 a[44:47], a[108:111], v[162:165], a[44:47]
    v_add_f32 v219, v219, v235
    v_add_f32 v216, v216, v236
    v_mfma_f32_16x16x32_bf16 a[44:47], a[124:127], v[166:169], a[44:47]
    v_add_f32 v217, v217, v237
    v_mfma_f32_16x16x32_bf16 a[44:47], a[128:131], v[170:173], a[44:47]
    v_add_f32 v218, v218, v238
    v_mfma_f32_16x16x32_bf16 a[44:47], a[132:135], v[174:177], a[44:47]
    v_add_f32 v219, v219, v239
    v_mfma_f32_16x16x32_bf16 a[44:47], a[148:151], v[178:181], a[44:47]
    v_add_f32 v216, v216, v240
    v_add_f32 v217, v217, v241
    v_mfma_f32_16x16x32_bf16 a[44:47], a[152:155], v[182:185], a[44:47]
    v_add_f32 v218, v218, v242
    v_mfma_f32_16x16x32_bf16 a[44:47], a[156:159], v[186:189], a[44:47]
    ds_write_b128 v51, a[40:43] offset:2048
    v_mfma_f32_16x16x32_bf16 a[48:51], a[112:115], v[154:157], a[48:51]
    v_add_f32 v219, v219, v243
    v_add_f32 v216, v216, v190
    v_mfma_f32_16x16x32_bf16 a[48:51], a[116:119], v[158:161], a[48:51]
    v_add_f32 v217, v217, v191
    v_mfma_f32_16x16x32_bf16 a[48:51], a[120:123], v[162:165], a[48:51]
    v_add_f32 v218, v218, v192
    v_mfma_f32_16x16x32_bf16 a[48:51], a[136:139], v[166:169], a[48:51]
    v_add_f32 v219, v219, v193
    v_mfma_f32_16x16x32_bf16 a[48:51], a[140:143], v[170:173], a[48:51]
    v_cvt_pk_bf16_f32 v32, v216, v217
    v_cvt_pk_bf16_f32 v33, v218, v219
    v_mfma_f32_16x16x32_bf16 a[48:51], a[144:147], v[174:177], a[48:51]
    buffer_store_dwordx2 v[32:33], v48, s[36:39], s88 offen offset:0
    v_mfma_f32_16x16x32_bf16 a[48:51], a[160:163], v[178:181], a[48:51]
    s_waitcnt lgkmcnt(2)
    v_add_f32 v220, v220, v244
    v_mfma_f32_16x16x32_bf16 a[48:51], a[164:167], v[182:185], a[48:51]
    v_add_f32 v221, v221, v245
    v_add_f32 v222, v222, v246
    v_mfma_f32_16x16x32_bf16 a[48:51], a[168:171], v[186:189], a[48:51]
    ds_write_b128 v51, a[44:47] offset:3072
    v_mfma_f32_16x16x32_bf16 a[52:55], a[124:127], v[154:157], a[52:55]
    v_add_f32 v223, v223, v247
    v_add_f32 v220, v220, v248
    v_mfma_f32_16x16x32_bf16 a[52:55], a[128:131], v[158:161], a[52:55]
    v_add_f32 v221, v221, v249
    v_mfma_f32_16x16x32_bf16 a[52:55], a[132:135], v[162:165], a[52:55]
    v_add_f32 v222, v222, v250
    v_add_f32 v223, v223, v251
    v_mfma_f32_16x16x32_bf16 a[52:55], a[148:151], v[166:169], a[52:55]
    v_add_f32 v220, v220, v252
    v_mfma_f32_16x16x32_bf16 a[52:55], a[152:155], v[170:173], a[52:55]
    v_add_f32 v221, v221, v253
    v_mfma_f32_16x16x32_bf16 a[52:55], a[156:159], v[174:177], a[52:55]
    v_add_f32 v222, v222, v254
    v_mfma_f32_16x16x32_bf16 a[52:55], a[172:175], v[178:181], a[52:55]
    v_add_f32 v223, v223, v255
    v_mfma_f32_16x16x32_bf16 a[52:55], a[176:179], v[182:185], a[52:55]
    v_add_f32 v220, v220, v194
    v_mfma_f32_16x16x32_bf16 a[52:55], a[180:183], v[186:189], a[52:55]
    ds_write_b128 v51, a[48:51] offset:4096
    v_mfma_f32_16x16x32_bf16 a[56:59], a[136:139], v[154:157], a[56:59]
    v_add_f32 v221, v221, v195
    v_add_f32 v222, v222, v196
    v_mfma_f32_16x16x32_bf16 a[56:59], a[140:143], v[158:161], a[56:59]
    v_add_f32 v223, v223, v197
    v_mfma_f32_16x16x32_bf16 a[56:59], a[144:147], v[162:165], a[56:59]
    v_cvt_pk_bf16_f32 v34, v220, v221
    v_cvt_pk_bf16_f32 v35, v222, v223
    v_mfma_f32_16x16x32_bf16 a[56:59], a[160:163], v[166:169], a[56:59]
    buffer_store_dwordx2 v[34:35], v48, s[36:39], s88 offen offset:32
    v_mfma_f32_16x16x32_bf16 a[56:59], a[164:167], v[170:173], a[56:59]
    v_mfma_f32_16x16x32_bf16 a[56:59], a[168:171], v[174:177], a[56:59]
    v_mfma_f32_16x16x32_bf16 a[56:59], a[184:187], v[178:181], a[56:59]
    v_mfma_f32_16x16x32_bf16 a[56:59], a[188:191], v[182:185], a[56:59]
    v_mfma_f32_16x16x32_bf16 a[56:59], a[192:195], v[186:189], a[56:59]
    ds_write_b128 v51, a[52:55] offset:5120
    v_mfma_f32_16x16x32_bf16 a[60:63], a[148:151], v[154:157], a[60:63]
    v_mfma_f32_16x16x32_bf16 a[60:63], a[152:155], v[158:161], a[60:63]
    v_mfma_f32_16x16x32_bf16 a[60:63], a[156:159], v[162:165], a[60:63]
    v_mfma_f32_16x16x32_bf16 a[60:63], a[172:175], v[166:169], a[60:63]
    v_mfma_f32_16x16x32_bf16 a[60:63], a[176:179], v[170:173], a[60:63]
    v_mfma_f32_16x16x32_bf16 a[60:63], a[180:183], v[174:177], a[60:63]
    v_mfma_f32_16x16x32_bf16 a[60:63], a[196:199], v[178:181], a[60:63]
    v_mfma_f32_16x16x32_bf16 a[60:63], a[200:203], v[182:185], a[60:63]
    v_mfma_f32_16x16x32_bf16 a[60:63], a[204:207], v[186:189], a[60:63]
    ds_write_b128 v51, a[56:59] offset:6144
    s_nop 7
    ds_write_b128 v51, a[60:63] offset:7168
    s_waitcnt lgkmcnt(0)
    s_barrier
    ds_read_b128 v[224:227], v52 offset:0
    ds_read_b128 v[232:235], v52 offset:40960
    ds_read_b128 v[236:239], v53 offset:0
    ds_read_b128 v[240:243], v53 offset:40960
    ds_read_b128 v[228:231], v52 offset:1024
    ds_read_b128 v[244:247], v52 offset:41984
    ds_read_b128 v[248:251], v53 offset:1024
    ds_read_b128 v[252:255], v53 offset:41984
    s_waitcnt lgkmcnt(4)
    v_pk_add_f32 v[224:225], v[224:225], v[232:233]
    v_pk_add_f32 v[226:227], v[226:227], v[234:235]
    v_pk_add_f32 v[224:225], v[224:225], v[236:237]
    v_pk_add_f32 v[226:227], v[226:227], v[238:239]
    v_pk_add_f32 v[224:225], v[224:225], v[240:241]
    v_pk_add_f32 v[226:227], v[226:227], v[242:243]
    v_pk_add_f32 v[224:225], v[224:225], v[198:199]
    v_pk_add_f32 v[226:227], v[226:227], v[200:201]
    v_cvt_pk_bf16_f32 v36, v224, v225
    v_cvt_pk_bf16_f32 v37, v226, v227
    buffer_store_dwordx2 v[36:37], v48, s[36:39], s89 offen offset:0
    s_waitcnt lgkmcnt(0)
    v_pk_add_f32 v[228:229], v[228:229], v[244:245]
    v_pk_add_f32 v[230:231], v[230:231], v[246:247]
    v_pk_add_f32 v[228:229], v[228:229], v[248:249]
    v_pk_add_f32 v[230:231], v[230:231], v[250:251]
    v_pk_add_f32 v[228:229], v[228:229], v[252:253]
    v_pk_add_f32 v[230:231], v[230:231], v[254:255]
    v_pk_add_f32 v[228:229], v[228:229], v[202:203]
    v_pk_add_f32 v[230:231], v[230:231], v[204:205]
    v_cvt_pk_bf16_f32 v38, v228, v229
    v_cvt_pk_bf16_f32 v39, v230, v231
    buffer_store_dwordx2 v[38:39], v48, s[36:39], s89 offen offset:32
L_end:
    s_endpgm
L_embslow:
    s_mov_b32 s70, 0
L_embslow2:
    buffer_load_dword v48, v54, s[28:31], s69 offen sc1
    s_waitcnt vmcnt(0)
    v_cmp_eq_u32 vcc, s54, v48
    s_add_u32 s70, s70, 1
    s_cmp_eq_u64 vcc, exec
    s_cbranch_scc1 L_embok
    s_cmp_lt_u32 s70, 0x40000
    s_cbranch_scc1 L_embslow2
    s_branch L_embok
.section .rodata,"a"
.p2align 6
.amdhsa_kernel standalone__adm_resblock__diffusion_kernel
  .amdhsa_next_free_vgpr 464
  .amdhsa_next_free_sgpr 102
  .amdhsa_accum_offset 256
  .amdhsa_group_segment_fixed_size 0
  .amdhsa_kernarg_size 96
  .amdhsa_user_sgpr_count 2
  .amdhsa_user_sgpr_kernarg_segment_ptr 1
  .amdhsa_system_sgpr_workgroup_id_x 1
.end_amdhsa_kernel
```
